```python
import torch

def _softmax(x, axis=-1):
    return torch.softmax(x, dim=axis)
def _gelu(x):
    return torch.nn.functional.gelu(x, approximate="tanh")
def _silu(x):
    return torch.nn.functional.silu(x)
def _sigmoid(x):
    return torch.sigmoid(x)
def _layernorm(x, axis=-1, eps=1e-5):
    m = x.mean(dim=axis, keepdim=True)
    v = x.var(dim=axis, keepdim=True, unbiased=False)
    return (x - m) / torch.sqrt(v + eps)
def _scatter_add(tgt, idx, src, axis=0):
    return tgt.clone().index_add_(axis, idx, src)
def _segment_sum(src, seg, n):
    out = torch.zeros((n,) + src.shape[1:], dtype=src.dtype)
    return out.index_add_(0, seg, src)
def _pad(x, pw):
    flat = tuple(v for pair in reversed(pw) for v in pair)
    return torch.nn.functional.pad(x, flat)

kernel_name = 'concat_heads__ssm_conv_s4d__ssm_conv_h3__prompt'

def setup_inputs():

    _w = (lambda a: (lambda t: t.to(torch.bfloat16) if t.is_floating_point() else t)(torch.as_tensor(a)))
    def _A_setup():
        Bsz, L, D, N = 1, 2048, 640, 128
        return {
            "u": _w((lambda *s: torch.randn(*s, dtype=torch.bfloat16) * 0.05)(Bsz, L, D)),
            "log_A_real": _w((lambda *s: torch.randn(*s, dtype=torch.bfloat16) * 3.2)(D, N) * 0.5),
            "A_imag": _w((lambda *s: torch.randn(*s, dtype=torch.bfloat16) * 0.05)(D, N) * 3.14),
            "C_real": _w((lambda *s: torch.randn(*s, dtype=torch.bfloat16) * 0.1)(D, N) / N ** 0.5),
            "C_imag": _w((lambda *s: torch.randn(*s, dtype=torch.bfloat16) * 0.1)(D, N) / N ** 0.5),
            "log_dt": _w((lambda *s: torch.randn(*s, dtype=torch.bfloat16) * 0.05)(D) * 0.5 - 4.0),
            "D_skip": _w((lambda *s: torch.randn(*s, dtype=torch.bfloat16) * 0.05)(D)),
        }
    _A_in = _A_setup()

    def _B_setup():
        B, S, D = 1, 2048, 640
        ks = 4
        return {
            "q": _w((lambda *s: torch.randn(*s, dtype=torch.bfloat16) * 0.05)(B, S, D)),
            "k": _w((lambda *s: torch.randn(*s, dtype=torch.bfloat16) * 0.4)(B, S, D)),
            "v": _w((lambda *s: torch.randn(*s, dtype=torch.bfloat16) * 0.2)(B, S, D)),
            "shift_k": _w((lambda *s: torch.randn(*s, dtype=torch.bfloat16) * 0.4)(D, ks) * 0.5),
            "ssm_k": _w((lambda *s: torch.randn(*s, dtype=torch.bfloat16) * 0.4)(D, S) * (1.0 / S ** 0.5)),
            "ssm_D": _w((lambda *s: torch.randn(*s, dtype=torch.bfloat16) * 0.2)(D)),
        }
    _B_in = _B_setup()

    return {
        "A_u": _A_in["u"],
        "A_log_A_real": _A_in["log_A_real"],
        "A_A_imag": _A_in["A_imag"],
        "A_C_real": _A_in["C_real"],
        "A_C_imag": _A_in["C_imag"],
        "A_log_dt": _A_in["log_dt"],
        "A_D_skip": _A_in["D_skip"],
        "B_q": _B_in["q"],
        "B_k": _B_in["k"],
        "B_v": _B_in["v"],
        "B_shift_k": _B_in["shift_k"],
        "B_ssm_k": _B_in["ssm_k"],
        "B_ssm_D": _B_in["ssm_D"],
    }

def reference(A_u, A_log_A_real, A_A_imag, A_C_real, A_C_imag, A_log_dt, A_D_skip, B_q, B_k, B_v, B_shift_k, B_ssm_k, B_ssm_D):
    def _A_ref(u, log_A_real, A_imag, C_real, C_imag, log_dt, D_skip):
        L = u.shape[1]
        dt = torch.exp(log_dt)
        A = -torch.exp(log_A_real) + 1j * A_imag
        C = (C_real + 1j * C_imag) * dt[:, None]
        pos = (lambda x, dt: x.to(dt))(torch.arange(L), log_dt.dtype)
        P = torch.exp((A * dt[:, None])[:, :, None] * pos[None, None, :])
        K = 2.0 * torch.einsum("dn,dnl->dl", C, P).real
        L2 = 2 * L
        u_t = (lambda x, *d: x.permute(*d))(u, 0, 2, 1)
        Kf = (lambda x, *a, **k: torch.fft.rfft(x.float(), *a, **k))(K, L2)
        Uf = (lambda x, *a, **k: torch.fft.rfft(x.float(), *a, **k))(u_t, L2)
        y = (lambda x, *a, **k: torch.fft.irfft(x, *a, **k).to(torch.bfloat16))(Uf * Kf[None, :, :], L2)[:, :, :L]
        y = (lambda x, *d: x.permute(*d))(y, 0, 2, 1)
        return y + u * D_skip[None, None, :]

    def _B_ref(q, k, v, shift_k, ssm_k, ssm_D):
        B, S, D = q.shape
        ks = shift_k.shape[-1]
        k_pad = _pad(k, ((0, 0), (ks - 1, 0), (0, 0)))
        k_shift = torch.zeros_like(k)
        for t in range(ks):
            k_shift = k_shift + k_pad[:, t:t + S, :] * shift_k[:, ks - 1 - t][None, None, :]
        kv = k_shift * v
        L = 2 * S
        kv_pad = _pad(kv, ((0, 0), (0, S), (0, 0)))
        kf_pad = _pad(ssm_k, ((0, 0), (0, S)))
        kv_f = (lambda x, axes=(-2,-1): torch.fft.rfft2(x.float(), dim=axes))(kv_pad[:, None, :, :], axes=(1, 2))
        kf_f = (lambda x, axes=(-2,-1): torch.fft.rfft2(x.float(), dim=axes))(kf_pad[:, None, :], axes=(1, 2))
        kf_f = (lambda x, *d: x.permute(*d))(kf_f, 1, 2, 0)
        y_f = kv_f * kf_f[None, :, :, :]
        y = (lambda x, s, axes=(-2,-1): torch.fft.irfft2(x, s=s, dim=axes).to(torch.bfloat16))(y_f, (1, L), axes=(1, 2))[:, 0, :S, :]
        y = y + kv * ssm_D[None, None, :]
        return q * y

    a = _A_ref(A_u, A_log_A_real, A_A_imag, A_C_real, A_C_imag, A_log_dt, A_D_skip)
    b = _B_ref(B_q, B_k, B_v, B_shift_k, B_ssm_k, B_ssm_D)
    return torch.concatenate([a, b], axis=-1)
```

```asm
; @launch grid=(256,1,1) block=(512,1,1) lds=163840
.amdgcn_target "amdgcn-amd-amdhsa--gfx950"
.text
.globl concat_heads__ssm_conv_s4d__ssm_conv_h3__prompt_kernel
.p2align 8
.type concat_heads__ssm_conv_s4d__ssm_conv_h3__prompt_kernel,@function
concat_heads__ssm_conv_s4d__ssm_conv_h3__prompt_kernel:
    s_cmp_ge_u32 s2, 256
    s_cbranch_scc1 L_END
    s_load_dwordx16 s[8:23], s[0:1], 0
    s_load_dwordx16 s[24:39], s[0:1], 64
    s_mov_b32 s92, 0
    s_getpc_b64 s[4:5]
L_PC:
    s_sub_u32 s4, s4, L_PC-concat_heads__ssm_conv_s4d__ssm_conv_h3__prompt_kernel
    s_subb_u32 s5, s5, 0
    s_lshr_b32 s3, s2, 3
    s_mul_i32 s3, s3, 10
    v_add_u32 v2, s3, v0
    v_lshlrev_b32 v2, 7, v2
    v_min_u32 v2, L_CODE_END-concat_heads__ssm_conv_s4d__ssm_conv_h3__prompt_kernel-4, v2
    v_mov_b32 v3, s5
    v_add_co_u32 v2, vcc, s4, v2
    s_nop 1
    v_addc_co_u32 v3, vcc, 0, v3, vcc
    v_cmp_gt_u32 vcc, 10, v0
    s_nop 1
    s_and_saveexec_b64 s[6:7], vcc
    s_cbranch_execz L_NOPF
    global_load_dword v252, v[2:3], off
L_NOPF:
    s_mov_b64 exec, -1
L_START:
    s_getreg_b32 s71, hwreg(HW_REG_XCC_ID, 0, 4)
    s_and_b32 s68, s2, 7
    s_lshr_b32 s69, s2, 3
    s_lshr_b32 s72, s68, 2
    s_xor_b32 s72, s72, 1
    s_and_b32 s73, s68, 3
    s_mul_i32 s73, s73, 160
    s_and_b32 s71, s71, 7
    v_and_b32 v1, 63, v0
    v_lshrrev_b32 v4, 6, v0
    s_nop 0
    v_readfirstlane_b32 s70, v4
    s_mov_b32 s76, 0xffff0000
    s_mov_b32 s77, 0x05040100
    s_mov_b32 s78, 0x07060302
    s_mov_b32 s82, 163840
    s_mov_b32 s83, 327680
    s_mov_b32 s84, 491520
    s_mov_b32 s100, 262144
    s_mov_b32 s101, 524288
    s_mov_b32 s80, 5120
    s_mov_b32 s81, 7680
    s_mul_i32 s75, s69, 5
    s_add_u32 s75, s75, s70
    s_add_u32 s74, s73, s75
    s_lshl_b32 s79, s75, 12
    s_waitcnt lgkmcnt(0)
    s_cmp_eq_u32 s72, 0
    s_cbranch_scc1 L_A1
    v_and_b32 v6, 15, v1
    v_lshlrev_b32 v6, 2, v6
    v_add_u32 v6, 163776, v6
    v_mov_b32 v7, 0
    ds_write_b32 v6, v7
    s_cmp_ge_u32 s70, 5
    s_cbranch_scc1 L_B5
    v_mul_u32_u24 v3, 1639, v0
    v_lshrrev_b32 v3, 16, v3
    v_mul_u32_u24 v2, 40, v3
    v_sub_u32 v2, v0, v2
    s_lshl_b32 s75, s69, 6
    v_lshlrev_b32 v4, 3, v3
    v_add_u32 v4, s75, v4
    v_mul_u32_u24 v4, 1280, v4
    s_lshl_b32 s75, s73, 1
    v_lshlrev_b32 v5, 3, v2
    v_add3_u32 v4, v4, v5, s75
    v_add_u32 v5, 5120, v4
    s_mov_b32 s40, s24
    s_mov_b32 s41, s25
    s_mov_b32 s42, 2621440
    s_mov_b32 s43, 0x20000
    buffer_load_dwordx2 v[16:17], v4, s[40:43], 0 offen offset:0
    buffer_load_dwordx2 v[18:19], v4, s[40:43], 0 offen offset:1280
    buffer_load_dwordx2 v[20:21], v4, s[40:43], 0 offen offset:2560
    buffer_load_dwordx2 v[22:23], v4, s[40:43], 0 offen offset:3840
    buffer_load_dwordx2 v[24:25], v5, s[40:43], 0 offen offset:0
    buffer_load_dwordx2 v[26:27], v5, s[40:43], 0 offen offset:1280
    buffer_load_dwordx2 v[28:29], v5, s[40:43], 0 offen offset:2560
    buffer_load_dwordx2 v[30:31], v5, s[40:43], 0 offen offset:3840
    s_mov_b32 s64, s28
    s_mov_b32 s65, s29
    s_mov_b32 s66, 5120
    s_mov_b32 s67, 0x20000
    s_lshl_b32 s75, s73, 3
    v_lshlrev_b32 v7, 5, v2
    v_add_u32 v7, s75, v7
    buffer_load_dwordx4 v[48:51], v7, s[64:67], 0 offen
    buffer_load_dwordx4 v[52:55], v7, s[64:67], 0 offen offset:16
    v_subrev_u32 v6, 3840, v4
    v_mov_b32 v7, 0x40000000
    v_cmp_gt_u32 vcc, 3840, v4
    s_nop 1
    v_cndmask_b32 v6, v6, v7, vcc
    buffer_load_dwordx2 v[10:11], v6, s[40:43], 0 offen offset:0
    buffer_load_dwordx2 v[12:13], v6, s[40:43], 0 offen offset:1280
    buffer_load_dwordx2 v[14:15], v6, s[40:43], 0 offen offset:2560
    s_mov_b32 s44, s26
    s_mov_b32 s45, s27
    s_mov_b32 s46, 2621440
    s_mov_b32 s47, 0x20000
    buffer_load_dwordx2 v[32:33], v4, s[44:47], 0 offen offset:0
    buffer_load_dwordx2 v[34:35], v4, s[44:47], 0 offen offset:1280
    buffer_load_dwordx2 v[36:37], v4, s[44:47], 0 offen offset:2560
    buffer_load_dwordx2 v[38:39], v4, s[44:47], 0 offen offset:3840
    buffer_load_dwordx2 v[40:41], v5, s[44:47], 0 offen offset:0
    buffer_load_dwordx2 v[42:43], v5, s[44:47], 0 offen offset:1280
    buffer_load_dwordx2 v[44:45], v5, s[44:47], 0 offen offset:2560
    buffer_load_dwordx2 v[46:47], v5, s[44:47], 0 offen offset:3840
    s_mul_i32 s75, s68, 655360
    s_add_u32 s52, s38, s75
    s_addc_u32 s53, s39, 0
    s_mov_b32 s54, 655360
    s_mov_b32 s55, 0x20000
    s_mov_b32 s60, s36
    s_mov_b32 s61, s37
    s_mov_b32 s62, 256
    s_mov_b32 s63, 0x20000
    s_mov_b32 s56, s34
    s_mov_b32 s57, s35
    s_mov_b32 s58, 5242880
    s_mov_b32 s59, 0x20000
    s_waitcnt lgkmcnt(0)
    s_barrier
    v_sub_u32 v6, 7, v3
    v_and_b32 v7, 7, v2
    v_xor_b32 v6, v6, v7
    v_lshlrev_b32 v6, 4, v6
    v_lshlrev_b32 v7, 9, v2
    v_add_u32 v7, 129600, v7
    v_add_u32 v236, v6, v7
    v_lshrrev_b32 v6, 3, v0
    v_and_b32 v7, 7, v0
    v_add_u32 v8, 0, v6
    v_lshrrev_b32 v9, 2, v8
    v_and_b32 v9, 7, v9
    v_xor_b32 v9, v9, v7
    v_lshlrev_b32 v9, 4, v9
    v_lshlrev_b32 v8, 7, v8
    v_add_u32 v8, 129600, v8
    v_add_u32 v240, v8, v9
    v_add_u32 v8, 40, v6
    v_lshrrev_b32 v9, 2, v8
    v_and_b32 v9, 7, v9
    v_xor_b32 v9, v9, v7
    v_lshlrev_b32 v9, 4, v9
    v_lshlrev_b32 v8, 7, v8
    v_add_u32 v8, 129600, v8
    v_add_u32 v241, v8, v9
    v_add_u32 v8, 80, v6
    v_lshrrev_b32 v9, 2, v8
    v_and_b32 v9, 7, v9
    v_xor_b32 v9, v9, v7
    v_lshlrev_b32 v9, 4, v9
    v_lshlrev_b32 v8, 7, v8
    v_add_u32 v8, 129600, v8
    v_add_u32 v242, v8, v9
    v_add_u32 v8, 120, v6
    v_lshrrev_b32 v9, 2, v8
    v_and_b32 v9, 7, v9
    v_xor_b32 v9, v9, v7
    v_lshlrev_b32 v9, 4, v9
    v_lshlrev_b32 v8, 7, v8
    v_add_u32 v8, 129600, v8
    v_add_u32 v243, v8, v9
    s_sub_u32 s75, 31, s69
    s_lshl_b32 s75, s75, 7
    v_lshlrev_b32 v6, 12, v6
    v_lshlrev_b32 v7, 4, v7
    v_add3_u32 v237, v6, v7, s75
    s_waitcnt vmcnt(8)
    v_lshlrev_b32 v108, 16, v48
    v_and_b32 v112, s76, v48
    v_lshlrev_b32 v116, 16, v49
    v_and_b32 v120, s76, v49
    v_lshlrev_b32 v109, 16, v50
    v_and_b32 v113, s76, v50
    v_lshlrev_b32 v117, 16, v51
    v_and_b32 v121, s76, v51
    v_lshlrev_b32 v110, 16, v52
    v_and_b32 v114, s76, v52
    v_lshlrev_b32 v118, 16, v53
    v_and_b32 v122, s76, v53
    v_lshlrev_b32 v111, 16, v54
    v_and_b32 v115, s76, v54
    v_lshlrev_b32 v119, 16, v55
    v_and_b32 v123, s76, v55
    v_lshlrev_b32 v124, 16, v10
    v_and_b32 v125, s76, v10
    v_lshlrev_b32 v126, 16, v11
    v_and_b32 v127, s76, v11
    v_lshlrev_b32 v128, 16, v12
    v_and_b32 v129, s76, v12
    v_lshlrev_b32 v130, 16, v13
    v_and_b32 v131, s76, v13
    v_lshlrev_b32 v132, 16, v14
    v_and_b32 v133, s76, v14
    v_lshlrev_b32 v134, 16, v15
    v_and_b32 v135, s76, v15
    v_lshlrev_b32 v136, 16, v16
    v_and_b32 v137, s76, v16
    v_lshlrev_b32 v138, 16, v17
    v_and_b32 v139, s76, v17
    v_lshlrev_b32 v140, 16, v18
    v_and_b32 v141, s76, v18
    v_lshlrev_b32 v142, 16, v19
    v_and_b32 v143, s76, v19
    v_lshlrev_b32 v144, 16, v20
    v_and_b32 v145, s76, v20
    v_lshlrev_b32 v146, 16, v21
    v_and_b32 v147, s76, v21
    v_lshlrev_b32 v148, 16, v22
    v_and_b32 v149, s76, v22
    v_lshlrev_b32 v150, 16, v23
    v_and_b32 v151, s76, v23
    v_lshlrev_b32 v152, 16, v24
    v_and_b32 v153, s76, v24
    v_lshlrev_b32 v154, 16, v25
    v_and_b32 v155, s76, v25
    v_lshlrev_b32 v156, 16, v26
    v_and_b32 v157, s76, v26
    v_lshlrev_b32 v158, 16, v27
    v_and_b32 v159, s76, v27
    v_lshlrev_b32 v160, 16, v28
    v_and_b32 v161, s76, v28
    v_lshlrev_b32 v162, 16, v29
    v_and_b32 v163, s76, v29
    v_lshlrev_b32 v164, 16, v30
    v_and_b32 v165, s76, v30
    v_lshlrev_b32 v166, 16, v31
    v_and_b32 v167, s76, v31
    v_pk_mul_f32 v[168:169], v[136:137], v[108:109]
    v_pk_mul_f32 v[170:171], v[138:139], v[110:111]
    v_pk_mul_f32 v[172:173], v[140:141], v[108:109]
    v_pk_mul_f32 v[174:175], v[142:143], v[110:111]
    v_pk_fma_f32 v[168:169], v[132:133], v[112:113], v[168:169]
    v_pk_fma_f32 v[170:171], v[134:135], v[114:115], v[170:171]
    v_pk_fma_f32 v[172:173], v[136:137], v[112:113], v[172:173]
    v_pk_fma_f32 v[174:175], v[138:139], v[114:115], v[174:175]
    v_pk_fma_f32 v[168:169], v[128:129], v[116:117], v[168:169]
    v_pk_fma_f32 v[170:171], v[130:131], v[118:119], v[170:171]
    v_pk_fma_f32 v[172:173], v[132:133], v[116:117], v[172:173]
    v_pk_fma_f32 v[174:175], v[134:135], v[118:119], v[174:175]
    v_pk_fma_f32 v[168:169], v[124:125], v[120:121], v[168:169]
    v_pk_fma_f32 v[170:171], v[126:127], v[122:123], v[170:171]
    v_pk_fma_f32 v[172:173], v[128:129], v[120:121], v[172:173]
    v_pk_fma_f32 v[174:175], v[130:131], v[122:123], v[174:175]
    v_pk_mul_f32 v[176:177], v[144:145], v[108:109]
    v_pk_mul_f32 v[178:179], v[146:147], v[110:111]
    v_pk_mul_f32 v[180:181], v[148:149], v[108:109]
    v_pk_mul_f32 v[182:183], v[150:151], v[110:111]
    v_pk_fma_f32 v[176:177], v[140:141], v[112:113], v[176:177]
    v_pk_fma_f32 v[178:179], v[142:143], v[114:115], v[178:179]
    v_pk_fma_f32 v[180:181], v[144:145], v[112:113], v[180:181]
    v_pk_fma_f32 v[182:183], v[146:147], v[114:115], v[182:183]
    v_pk_fma_f32 v[176:177], v[136:137], v[116:117], v[176:177]
    v_pk_fma_f32 v[178:179], v[138:139], v[118:119], v[178:179]
    v_pk_fma_f32 v[180:181], v[140:141], v[116:117], v[180:181]
    v_pk_fma_f32 v[182:183], v[142:143], v[118:119], v[182:183]
    v_pk_fma_f32 v[176:177], v[132:133], v[120:121], v[176:177]
    v_pk_fma_f32 v[178:179], v[134:135], v[122:123], v[178:179]
    v_pk_fma_f32 v[180:181], v[136:137], v[120:121], v[180:181]
    v_pk_fma_f32 v[182:183], v[138:139], v[122:123], v[182:183]
    v_pk_mul_f32 v[184:185], v[152:153], v[108:109]
    v_pk_mul_f32 v[186:187], v[154:155], v[110:111]
    v_pk_mul_f32 v[188:189], v[156:157], v[108:109]
    v_pk_mul_f32 v[190:191], v[158:159], v[110:111]
    v_pk_fma_f32 v[184:185], v[148:149], v[112:113], v[184:185]
    v_pk_fma_f32 v[186:187], v[150:151], v[114:115], v[186:187]
    v_pk_fma_f32 v[188:189], v[152:153], v[112:113], v[188:189]
    v_pk_fma_f32 v[190:191], v[154:155], v[114:115], v[190:191]
    v_pk_fma_f32 v[184:185], v[144:145], v[116:117], v[184:185]
    v_pk_fma_f32 v[186:187], v[146:147], v[118:119], v[186:187]
    v_pk_fma_f32 v[188:189], v[148:149], v[116:117], v[188:189]
    v_pk_fma_f32 v[190:191], v[150:151], v[118:119], v[190:191]
    v_pk_fma_f32 v[184:185], v[140:141], v[120:121], v[184:185]
    v_pk_fma_f32 v[186:187], v[142:143], v[122:123], v[186:187]
    v_pk_fma_f32 v[188:189], v[144:145], v[120:121], v[188:189]
    v_pk_fma_f32 v[190:191], v[146:147], v[122:123], v[190:191]
    v_pk_mul_f32 v[192:193], v[160:161], v[108:109]
    v_pk_mul_f32 v[194:195], v[162:163], v[110:111]
    v_pk_mul_f32 v[196:197], v[164:165], v[108:109]
    v_pk_mul_f32 v[198:199], v[166:167], v[110:111]
    v_pk_fma_f32 v[192:193], v[156:157], v[112:113], v[192:193]
    v_pk_fma_f32 v[194:195], v[158:159], v[114:115], v[194:195]
    v_pk_fma_f32 v[196:197], v[160:161], v[112:113], v[196:197]
    v_pk_fma_f32 v[198:199], v[162:163], v[114:115], v[198:199]
    v_pk_fma_f32 v[192:193], v[152:153], v[116:117], v[192:193]
    v_pk_fma_f32 v[194:195], v[154:155], v[118:119], v[194:195]
    v_pk_fma_f32 v[196:197], v[156:157], v[116:117], v[196:197]
    v_pk_fma_f32 v[198:199], v[158:159], v[118:119], v[198:199]
    v_pk_fma_f32 v[192:193], v[148:149], v[120:121], v[192:193]
    v_pk_fma_f32 v[194:195], v[150:151], v[122:123], v[194:195]
    v_pk_fma_f32 v[196:197], v[152:153], v[120:121], v[196:197]
    v_pk_fma_f32 v[198:199], v[154:155], v[122:123], v[198:199]
    s_waitcnt vmcnt(0)
    v_lshlrev_b32 v124, 16, v32
    v_and_b32 v125, s76, v32
    v_lshlrev_b32 v126, 16, v33
    v_and_b32 v127, s76, v33
    v_lshlrev_b32 v128, 16, v34
    v_and_b32 v129, s76, v34
    v_lshlrev_b32 v130, 16, v35
    v_and_b32 v131, s76, v35
    v_lshlrev_b32 v132, 16, v36
    v_and_b32 v133, s76, v36
    v_lshlrev_b32 v134, 16, v37
    v_and_b32 v135, s76, v37
    v_lshlrev_b32 v136, 16, v38
    v_and_b32 v137, s76, v38
    v_lshlrev_b32 v138, 16, v39
    v_and_b32 v139, s76, v39
    v_lshlrev_b32 v140, 16, v40
    v_and_b32 v141, s76, v40
    v_lshlrev_b32 v142, 16, v41
    v_and_b32 v143, s76, v41
    v_lshlrev_b32 v144, 16, v42
    v_and_b32 v145, s76, v42
    v_lshlrev_b32 v146, 16, v43
    v_and_b32 v147, s76, v43
    v_lshlrev_b32 v148, 16, v44
    v_and_b32 v149, s76, v44
    v_lshlrev_b32 v150, 16, v45
    v_and_b32 v151, s76, v45
    v_lshlrev_b32 v152, 16, v46
    v_and_b32 v153, s76, v46
    v_lshlrev_b32 v154, 16, v47
    v_and_b32 v155, s76, v47
    v_pk_mul_f32 v[168:169], v[168:169], v[124:125]
    v_pk_mul_f32 v[172:173], v[172:173], v[128:129]
    v_pk_mul_f32 v[176:177], v[176:177], v[132:133]
    v_pk_mul_f32 v[180:181], v[180:181], v[136:137]
    v_pk_mul_f32 v[184:185], v[184:185], v[140:141]
    v_pk_mul_f32 v[188:189], v[188:189], v[144:145]
    v_pk_mul_f32 v[192:193], v[192:193], v[148:149]
    v_pk_mul_f32 v[196:197], v[196:197], v[152:153]
    v_cvt_pk_bf16_f32 v200, v196, v192
    v_cvt_pk_bf16_f32 v201, v188, v184
    v_cvt_pk_bf16_f32 v202, v180, v176
    v_cvt_pk_bf16_f32 v203, v172, v168
    ds_write_b128 v236, v[200:203] offset:0
    v_cvt_pk_bf16_f32 v204, v197, v193
    v_cvt_pk_bf16_f32 v205, v189, v185
    v_cvt_pk_bf16_f32 v206, v181, v177
    v_cvt_pk_bf16_f32 v207, v173, v169
    ds_write_b128 v236, v[204:207] offset:128
    v_pk_mul_f32 v[170:171], v[170:171], v[126:127]
    v_pk_mul_f32 v[174:175], v[174:175], v[130:131]
    v_pk_mul_f32 v[178:179], v[178:179], v[134:135]
    v_pk_mul_f32 v[182:183], v[182:183], v[138:139]
    v_pk_mul_f32 v[186:187], v[186:187], v[142:143]
    v_pk_mul_f32 v[190:191], v[190:191], v[146:147]
    v_pk_mul_f32 v[194:195], v[194:195], v[150:151]
    v_pk_mul_f32 v[198:199], v[198:199], v[154:155]
    v_cvt_pk_bf16_f32 v208, v198, v194
    v_cvt_pk_bf16_f32 v209, v190, v186
    v_cvt_pk_bf16_f32 v210, v182, v178
    v_cvt_pk_bf16_f32 v211, v174, v170
    ds_write_b128 v236, v[208:211] offset:256
    v_cvt_pk_bf16_f32 v212, v199, v195
    v_cvt_pk_bf16_f32 v213, v191, v187
    v_cvt_pk_bf16_f32 v214, v183, v179
    v_cvt_pk_bf16_f32 v215, v175, v171
    ds_write_b128 v236, v[212:215] offset:384
    s_waitcnt lgkmcnt(0)
    v_mov_b32 v250, 163788
    v_mov_b32 v247, 1
    s_mov_b64 exec, 1
    ds_add_u32 v250, v247
    s_mov_b64 exec, -1
    v_mov_b32 v250, 163788
    s_mov_b32 s4, 0
L_go373:
    ds_read_b32 v247, v250
    s_add_u32 s4, s4, 1
    s_waitcnt lgkmcnt(0)
    v_readfirstlane_b32 s3, v247
    s_cmp_ge_u32 s4, 0x1000000
    s_cbranch_scc1 L_gx373
    s_cmp_lt_u32 s3, 5
    s_cbranch_scc0 L_gx373
    s_sleep 1
    s_branch L_go373
L_gx373:
    ds_read_b128 v[220:223], v240
    ds_read_b128 v[224:227], v241
    ds_read_b128 v[228:231], v242
    ds_read_b128 v[232:235], v243
    s_waitcnt lgkmcnt(3)
    buffer_store_dwordx4 v[220:223], v237, s[52:55], 0 offen
    s_waitcnt lgkmcnt(2)
    buffer_store_dwordx4 v[224:227], v237, s[52:55], s82 offen
    s_waitcnt lgkmcnt(1)
    buffer_store_dwordx4 v[228:231], v237, s[52:55], s83 offen
    s_waitcnt lgkmcnt(0)
    buffer_store_dwordx4 v[232:235], v237, s[52:55], s84 offen
    s_cmp_eq_u32 s92, 0
    s_cbranch_scc1 L_us399
    buffer_store_dwordx4 v[220:223], v237, s[52:55], 0 offen sc1
    buffer_store_dwordx4 v[224:227], v237, s[52:55], s82 offen sc1
    buffer_store_dwordx4 v[228:231], v237, s[52:55], s83 offen sc1
    buffer_store_dwordx4 v[232:235], v237, s[52:55], s84 offen sc1
    s_waitcnt vmcnt(0)
L_us399:
    s_sub_u32 s4, 31, s69
    s_lshl_b32 s4, s4, 7
    s_lshl_b32 s3, s92, 30
    s_add_u32 s4, s4, s3
    v_lshlrev_b32 v9, 12, v0
    v_add_u32 v9, s4, v9
    buffer_load_dword v251, v9, s[52:55], 0 offen
    s_waitcnt vmcnt(1)
    v_mov_b32 v250, 163784
    v_mov_b32 v247, 1
    s_mov_b64 exec, 1
    ds_add_rtn_u32 v247, v250, v247
    s_mov_b64 exec, -1
    s_waitcnt lgkmcnt(0)
    v_readfirstlane_b32 s3, v247
    s_nop 1
    s_cmp_lg_u32 s3, 4
    s_cbranch_scc1 L_sa415
    s_lshl_b32 s75, s68, 5
    s_add_u32 s75, s75, s69
    s_mov_b64 exec, 1
    s_cmp_eq_u32 s92, 0
    s_cbranch_scc0 L_sf424
    s_or_b32 s3, s71, 8
    v_mov_b32 v250, s75
    v_mov_b32 v247, s3
    buffer_store_byte v247, v250, s[60:63], 0 offen
    s_branch L_rf424
L_sf424:
    s_and_b32 s3, s75, 3
    s_lshl_b32 s3, s3, 3
    s_or_b32 s4, s71, 192
    s_lshl_b32 s4, s4, s3
    s_and_b32 s3, s75, 0xfc
    v_mov_b32 v250, s3
    v_mov_b32 v247, s4
    buffer_atomic_or v247, v250, s[60:63], 0 offen sc1
L_rf424:
    s_mov_b64 exec, -1
L_sa415:
    v_mov_b32 v250, 163792
    s_mov_b32 s4, 0
L_go446:
    ds_read_b32 v247, v250
    s_add_u32 s4, s4, 1
    s_waitcnt lgkmcnt(0)
    v_readfirstlane_b32 s3, v247
    s_cmp_ge_u32 s4, 0x1000000
    s_cbranch_scc1 L_gx446
    s_cmp_lt_u32 s3, 1
    s_cbranch_scc0 L_gx446
    s_sleep 1
    s_branch L_go446
L_gx446:
    s_mul_i32 s86, s70, 16640
    v_lshlrev_b32 v7, 2, v1
    v_add_u32 v7, s86, v7
    ds_read_b32 v96, v7 offset:12528
    ds_read_b32 v97, v7 offset:12784
    ds_read_b32 v98, v7 offset:13040
    ds_read_b32 v99, v7 offset:13296
    ds_read_b32 v100, v7 offset:13552
    ds_read_b32 v101, v7 offset:13808
    ds_read_b32 v102, v7 offset:14064
    ds_read_b32 v103, v7 offset:14320
    ds_read_b32 v104, v7 offset:14576
    ds_read_b32 v105, v7 offset:14832
    ds_read_b32 v106, v7 offset:15088
    ds_read_b32 v107, v7 offset:15344
    ds_read_b32 v108, v7 offset:15600
    ds_read_b32 v109, v7 offset:15856
    ds_read_b32 v110, v7 offset:16112
    ds_read_b32 v111, v7 offset:16368
    s_waitcnt lgkmcnt(8)
    ds_read_b32 v112, v7 offset:12532
    ds_read_b32 v113, v7 offset:12788
    ds_read_b32 v114, v7 offset:13044
    ds_read_b32 v115, v7 offset:13300
    ds_read_b32 v116, v7 offset:13556
    ds_read_b32 v117, v7 offset:13812
    ds_read_b32 v118, v7 offset:14068
    ds_read_b32 v119, v7 offset:14324
    ds_read_b32 v120, v7 offset:14580
    ds_read_b32 v121, v7 offset:14836
    ds_read_b32 v122, v7 offset:15092
    ds_read_b32 v123, v7 offset:15348
    ds_read_b32 v124, v7 offset:15604
    ds_read_b32 v125, v7 offset:15860
    ds_read_b32 v126, v7 offset:16116
    ds_read_b32 v127, v7 offset:16372
    s_waitcnt lgkmcnt(0)
    s_mov_b32 s75, s86
    s_mov_b32 m0, s75
    v_readlane_b32 s3, v96, 0
    v_lshlrev_b32 v6, 2, v1
    v_add_u32 v6, s75, v6
    s_lshl_b32 s3, s3, 16
    v_mov_b32 v7, 0
    v_mov_b32 v244, s3
    v_cmp_eq_u32 vcc, 13, v1
    s_nop 1
    v_cndmask_b32 v245, v7, v244, vcc
    v_cmp_eq_u32 vcc, 12, v1
    s_nop 1
    v_cndmask_b32 v244, v7, v244, vcc
    s_mov_b64 exec, 0x3fff
    ds_write_b32 v6, v245
    ds_write_b32 v6, v7 offset:4160
    ds_write_b32 v6, v244 offset:8320
    s_mov_b64 exec, 0xfff
    ds_write_b32 v6, v7 offset:12480
    s_mov_b64 exec, -1
    ds_write_addtid_b32 v96 offset:4212
    v_alignbit_b32 v112, v112, v96, 16
    ds_write_addtid_b32 v97 offset:4468
    v_alignbit_b32 v113, v113, v97, 16
    ds_write_addtid_b32 v98 offset:4724
    v_alignbit_b32 v114, v114, v98, 16
    ds_write_addtid_b32 v99 offset:4980
    v_alignbit_b32 v115, v115, v99, 16
    ds_write_addtid_b32 v100 offset:5236
    v_alignbit_b32 v116, v116, v100, 16
    ds_write_addtid_b32 v101 offset:5492
    v_alignbit_b32 v117, v117, v101, 16
    ds_write_addtid_b32 v102 offset:5748
    v_alignbit_b32 v118, v118, v102, 16
    ds_write_addtid_b32 v103 offset:6004
    v_alignbit_b32 v119, v119, v103, 16
    ds_write_addtid_b32 v104 offset:6260
    v_alignbit_b32 v120, v120, v104, 16
    ds_write_addtid_b32 v105 offset:6516
    v_alignbit_b32 v121, v121, v105, 16
    ds_write_addtid_b32 v106 offset:6772
    v_alignbit_b32 v122, v122, v106, 16
    ds_write_addtid_b32 v107 offset:7028
    v_alignbit_b32 v123, v123, v107, 16
    ds_write_addtid_b32 v108 offset:7284
    v_alignbit_b32 v124, v124, v108, 16
    ds_write_addtid_b32 v109 offset:7540
    v_alignbit_b32 v125, v125, v109, 16
    ds_write_addtid_b32 v110 offset:7796
    v_alignbit_b32 v126, v126, v110, 16
    ds_write_addtid_b32 v111 offset:8052
    v_alignbit_b32 v127, v127, v111, 16
    ds_write_addtid_b32 v112 offset:56
    ds_write_addtid_b32 v112 offset:8372
    ds_write_addtid_b32 v113 offset:312
    ds_write_addtid_b32 v113 offset:8628
    ds_write_addtid_b32 v114 offset:568
    ds_write_addtid_b32 v114 offset:8884
    ds_write_addtid_b32 v115 offset:824
    ds_write_addtid_b32 v115 offset:9140
    ds_write_addtid_b32 v116 offset:1080
    ds_write_addtid_b32 v116 offset:9396
    ds_write_addtid_b32 v117 offset:1336
    ds_write_addtid_b32 v117 offset:9652
    ds_write_addtid_b32 v118 offset:1592
    ds_write_addtid_b32 v118 offset:9908
    ds_write_addtid_b32 v119 offset:1848
    ds_write_addtid_b32 v119 offset:10164
    ds_write_addtid_b32 v120 offset:2104
    ds_write_addtid_b32 v120 offset:10420
    ds_write_addtid_b32 v121 offset:2360
    ds_write_addtid_b32 v121 offset:10676
    ds_write_addtid_b32 v122 offset:2616
    ds_write_addtid_b32 v122 offset:10932
    ds_write_addtid_b32 v123 offset:2872
    ds_write_addtid_b32 v123 offset:11188
    ds_write_addtid_b32 v124 offset:3128
    ds_write_addtid_b32 v124 offset:11444
    ds_write_addtid_b32 v125 offset:3384
    ds_write_addtid_b32 v125 offset:11700
    ds_write_addtid_b32 v126 offset:3640
    ds_write_addtid_b32 v126 offset:11956
    ds_write_addtid_b32 v127 offset:3896
    ds_write_addtid_b32 v127 offset:12212
    v_and_b32 v6, 15, v1
    v_lshrrev_b32 v7, 4, v1
    v_and_b32 v8, 3, v6
    v_mul_u32_u24 v8, 4160, v8
    v_lshrrev_b32 v9, 2, v6
    v_add_u32 v9, v9, v7
    v_lshlrev_b32 v9, 4, v9
    v_add_u32 v8, v8, v9
    s_mul_i32 s75, s70, 16640
    v_add_u32 v200, s75, v8
    s_lshl_b32 s75, s70, 7
    s_add_u32 s75, s75, 66560
    v_add_u32 v202, s75, v8
    v_and_b32 v8, 1, v6
    v_mul_u32_u24 v8, 4640, v8
    v_lshrrev_b32 v9, 1, v6
    v_lshlrev_b32 v9, 6, v9
    v_sub_u32 v8, v8, v9
    v_lshlrev_b32 v9, 4, v7
    v_add_u32 v8, v8, v9
    v_add_u32 v8, 83664, v8
    s_mul_i32 s75, s70, 9280
    v_add_u32 v201, s75, v8
    s_lshl_b32 s75, s70, 7
    s_add_u32 s75, s75, 37120
    v_add_u32 v203, s75, v8
    v_and_b32 v8, 1, v6
    v_lshlrev_b32 v8, 3, v8
    v_lshrrev_b32 v9, 1, v6
    v_lshlrev_b32 v9, 6, v9
    v_add_u32 v8, v8, v9
    v_lshlrev_b32 v9, 4, v7
    v_add_u32 v248, v8, v9
    v_lshlrev_b32 v246, 4, v1
    s_lshl_b32 s75, s70, 13
    s_add_u32 s75, s75, 129600
    v_add_u32 v246, s75, v246
    v_mul_u32_u24 v3, 1639, v0
    v_lshrrev_b32 v3, 16, v3
    v_mul_u32_u24 v2, 40, v3
    v_sub_u32 v2, v0, v2
    s_lshl_b32 s75, s69, 6
    v_lshlrev_b32 v229, 3, v3
    v_add_u32 v229, s75, v229
    v_mul_u32_u24 v229, 1280, v229
    s_lshl_b32 s75, s73, 1
    v_lshlrev_b32 v228, 3, v2
    v_add3_u32 v229, v229, v228, s75
    v_add_u32 v228, 5120, v229
    s_mov_b32 s48, s22
    s_mov_b32 s49, s23
    s_mul_i32 s50, s72, 2621440
    s_mov_b32 s51, 0x20000
    s_mul_i32 s86, s70, 9280
    s_add_u32 s86, s86, 83200
    v_lshlrev_b32 v7, 3, v1
    v_add_u32 v7, s86, v7
    v_mov_b32 v244, 0
    v_mov_b32 v245, 0
    s_mov_b32 exec_hi, 0x03ffffff
    ds_write_b64 v7, v[244:245] offset:4104
    ds_write_b64 v7, v[244:245] offset:8752
    s_mov_b64 exec, -1
    v_mov_b32 v250, 163776
    s_mov_b32 s4, 0
L_go643:
    ds_read_b32 v247, v250
    s_add_u32 s4, s4, 1
    s_waitcnt lgkmcnt(0)
    v_readfirstlane_b32 s3, v247
    s_cmp_ge_u32 s4, 0x1000000
    s_cbranch_scc1 L_gx643
    s_cmp_lt_u32 s3, 1
    s_cbranch_scc0 L_gx643
    s_sleep 1
    s_branch L_go643
L_gx643:
    s_mov_b32 s97, s3
    v_lshlrev_b32 v6, 4, v1
    buffer_load_dwordx4 v[72:75], v6, s[52:55], s79 offen offset:0 sc1
    buffer_load_dwordx4 v[76:79], v6, s[52:55], s79 offen offset:1024 sc1
    buffer_load_dwordx4 v[80:83], v6, s[52:55], s79 offen offset:2048 sc1
    buffer_load_dwordx4 v[84:87], v6, s[52:55], s79 offen offset:3072 sc1
    v_lshlrev_b32 v6, 4, v1
    v_add_u32 v6, s86, v6
    s_waitcnt vmcnt(3)
    ds_write_b128 v6, v[72:75] offset:4656
    ds_write_b64 v6, v[72:73] offset:8
    ds_write_b64 v6, v[74:75] offset:16
    s_waitcnt vmcnt(2)
    ds_write_b128 v6, v[76:79] offset:5680
    ds_write_b64 v6, v[76:77] offset:1032
    ds_write_b64 v6, v[78:79] offset:1040
    s_waitcnt vmcnt(1)
    ds_write_b128 v6, v[80:83] offset:6704
    ds_write_b64 v6, v[80:81] offset:2056
    ds_write_b64 v6, v[82:83] offset:2064
    s_waitcnt vmcnt(0)
    ds_write_b128 v6, v[84:87] offset:7728
    ds_write_b64 v6, v[84:85] offset:3080
    ds_write_b64 v6, v[86:87] offset:3088
    s_cmp_lg_u32 s70, 4
    s_cbranch_scc1 L_only681
    s_waitcnt lgkmcnt(0)
    v_mov_b32 v250, 163796
    v_mov_b32 v247, 2
    ds_write_b32 v250, v247
L_only681:
    s_mov_b32 s3, s97
    s_branch L_CVK
L_B5:
    s_mul_i32 s75, s68, 655360
    s_add_u32 s52, s38, s75
    s_addc_u32 s53, s39, 0
    s_mov_b32 s54, 655360
    s_mov_b32 s55, 0x20000
    s_mov_b32 s60, s36
    s_mov_b32 s61, s37
    s_mov_b32 s62, 256
    s_mov_b32 s63, 0x20000
    s_mov_b32 s56, s34
    s_mov_b32 s57, s35
    s_mov_b32 s58, 5242880
    s_mov_b32 s59, 0x20000
    s_cmp_lg_u32 s70, 6
    s_cbranch_scc1 L_only704
    s_lshl_b32 s75, s68, 5
    s_lshl_b32 s3, s92, 30
    s_add_u32 s75, s75, s3
    v_mov_b32 v9, s75
    buffer_load_dword v252, v9, s[60:63], 0 offen
L_only704:
    s_waitcnt lgkmcnt(0)
    s_barrier
    s_cmp_ge_u32 s70, 6
    s_cbranch_scc1 L_B6
    s_mov_b32 s44, s32
    s_mov_b32 s45, s33
    s_mov_b32 s46, 1280
    s_mov_b32 s47, 0x20000
    s_mul_i32 s4, s69, 5
    s_add_u32 s4, s4, s73
    v_add_u32 v9, s4, v1
    v_lshlrev_b32 v9, 1, v9
    buffer_load_ushort v95, v9, s[44:47], 0 offen
    s_lshl_b32 s75, s4, 12
    s_add_u32 s64, s30, s75
    s_addc_u32 s65, s31, 0
    s_mov_b32 s66, 20480
    s_mov_b32 s67, 0x20000
    v_lshlrev_b32 v8, 4, v1
    s_mov_b32 s3, 0
    buffer_load_dwordx4 v[10:13], v8, s[64:67], s3 offen offset:0
    buffer_load_dwordx4 v[14:17], v8, s[64:67], s3 offen offset:1024
    buffer_load_dwordx4 v[18:21], v8, s[64:67], s3 offen offset:2048
    buffer_load_dwordx4 v[22:25], v8, s[64:67], s3 offen offset:3072
    s_mov_b32 s3, 4096
    buffer_load_dwordx4 v[26:29], v8, s[64:67], s3 offen offset:0
    buffer_load_dwordx4 v[30:33], v8, s[64:67], s3 offen offset:1024
    buffer_load_dwordx4 v[34:37], v8, s[64:67], s3 offen offset:2048
    buffer_load_dwordx4 v[38:41], v8, s[64:67], s3 offen offset:3072
    s_mov_b32 s3, 8192
    buffer_load_dwordx4 v[42:45], v8, s[64:67], s3 offen offset:0
    buffer_load_dwordx4 v[46:49], v8, s[64:67], s3 offen offset:1024
    buffer_load_dwordx4 v[50:53], v8, s[64:67], s3 offen offset:2048
    buffer_load_dwordx4 v[54:57], v8, s[64:67], s3 offen offset:3072
    s_mov_b32 s3, 12288
    buffer_load_dwordx4 v[58:61], v8, s[64:67], s3 offen offset:0
    buffer_load_dwordx4 v[62:65], v8, s[64:67], s3 offen offset:1024
    buffer_load_dwordx4 v[66:69], v8, s[64:67], s3 offen offset:2048
    buffer_load_dwordx4 v[70:73], v8, s[64:67], s3 offen offset:3072
    s_mov_b32 s3, 16384
    buffer_load_dwordx4 v[74:77], v8, s[64:67], s3 offen offset:0
    buffer_load_dwordx4 v[78:81], v8, s[64:67], s3 offen offset:1024
    buffer_load_dwordx4 v[82:85], v8, s[64:67], s3 offen offset:2048
    buffer_load_dwordx4 v[86:89], v8, s[64:67], s3 offen offset:3072
    s_mov_b32 s5, 0xffff
    s_waitcnt vmcnt(16)
    v_readlane_b32 s3, v95, 0
    s_nop 1
    s_lshl_b32 s3, s3, 16
    s_mov_b64 exec, 1
    v_lshlrev_b32 v96, 16, v10
    v_add_f32 v96, s3, v96
    v_cvt_pk_bf16_f32 v96, v96, v96
    v_bfi_b32 v10, s5, v96, v10
    s_mov_b64 exec, -1
    v_lshlrev_b32 v6, 4, v1
    v_add_u32 v6, 0, v6
    ds_write_b128 v6, v[10:13] offset:12528
    ds_write_b128 v6, v[14:17] offset:13552
    ds_write_b128 v6, v[18:21] offset:14576
    ds_write_b128 v6, v[22:25] offset:15600
    s_waitcnt vmcnt(12)
    v_readlane_b32 s3, v95, 1
    s_nop 1
    s_lshl_b32 s3, s3, 16
    s_mov_b64 exec, 1
    v_lshlrev_b32 v96, 16, v26
    v_add_f32 v96, s3, v96
    v_cvt_pk_bf16_f32 v96, v96, v96
    v_bfi_b32 v26, s5, v96, v26
    s_mov_b64 exec, -1
    v_lshlrev_b32 v6, 4, v1
    v_add_u32 v6, 16640, v6
    ds_write_b128 v6, v[26:29] offset:12528
    ds_write_b128 v6, v[30:33] offset:13552
    ds_write_b128 v6, v[34:37] offset:14576
    ds_write_b128 v6, v[38:41] offset:15600
    s_waitcnt vmcnt(8)
    v_readlane_b32 s3, v95, 2
    s_nop 1
    s_lshl_b32 s3, s3, 16
    s_mov_b64 exec, 1
    v_lshlrev_b32 v96, 16, v42
    v_add_f32 v96, s3, v96
    v_cvt_pk_bf16_f32 v96, v96, v96
    v_bfi_b32 v42, s5, v96, v42
    s_mov_b64 exec, -1
    v_lshlrev_b32 v6, 4, v1
    v_add_u32 v6, 33280, v6
    ds_write_b128 v6, v[42:45] offset:12528
    ds_write_b128 v6, v[46:49] offset:13552
    ds_write_b128 v6, v[50:53] offset:14576
    ds_write_b128 v6, v[54:57] offset:15600
    s_waitcnt vmcnt(4)
    v_readlane_b32 s3, v95, 3
    s_nop 1
    s_lshl_b32 s3, s3, 16
    s_mov_b64 exec, 1
    v_lshlrev_b32 v96, 16, v58
    v_add_f32 v96, s3, v96
    v_cvt_pk_bf16_f32 v96, v96, v96
    v_bfi_b32 v58, s5, v96, v58
    s_mov_b64 exec, -1
    v_lshlrev_b32 v6, 4, v1
    v_add_u32 v6, 49920, v6
    ds_write_b128 v6, v[58:61] offset:12528
    ds_write_b128 v6, v[62:65] offset:13552
    ds_write_b128 v6, v[66:69] offset:14576
    ds_write_b128 v6, v[70:73] offset:15600
    s_waitcnt vmcnt(0)
    v_readlane_b32 s3, v95, 4
    s_nop 1
    s_lshl_b32 s3, s3, 16
    s_mov_b64 exec, 1
    v_lshlrev_b32 v96, 16, v74
    v_add_f32 v96, s3, v96
    v_cvt_pk_bf16_f32 v96, v96, v96
    v_bfi_b32 v74, s5, v96, v74
    s_mov_b64 exec, -1
    v_lshlrev_b32 v6, 4, v1
    v_add_u32 v6, 66560, v6
    ds_write_b128 v6, v[74:77] offset:12528
    ds_write_b128 v6, v[78:81] offset:13552
    ds_write_b128 v6, v[82:85] offset:14576
    ds_write_b128 v6, v[86:89] offset:15600
    s_waitcnt lgkmcnt(0)
    v_mov_b32 v250, 163792
    v_mov_b32 v247, 1
    ds_write_b32 v250, v247
    v_mov_b32 v250, 163784
    s_mov_b32 s4, 0
L_go836:
    ds_read_b32 v247, v250
    s_add_u32 s4, s4, 1
    s_waitcnt lgkmcnt(0)
    v_readfirstlane_b32 s3, v247
    s_cmp_ge_u32 s4, 0x1000000
    s_cbranch_scc1 L_gx836
    s_cmp_lt_u32 s3, 5
    s_cbranch_scc0 L_gx836
    s_sleep 1
    s_branch L_go836
L_gx836:
    s_lshl_b32 s5, s68, 5
    v_and_b32 v249, 7, v1
    v_cmp_gt_u32 vcc, 4, v249
    v_lshlrev_b32 v249, 2, v249
    v_add_u32 v249, s5, v249
    v_mov_b32 v242, 0xf0f0f0f
    v_mov_b32 v241, 0xf0f0f0f
    v_cndmask_b32 v242, v242, v241, vcc
    s_mul_i32 s85, s71, 16843009
    v_and_b32 v241, 0xf8f8f8f8, v242
    v_or_b32 v241, s85, v241
    s_mov_b32 s87, 0
    s_mov_b32 s6, 0
    s_cmp_eq_u32 s92, 0
    s_cbranch_scc0 L_ps850
L_pl850:
    buffer_load_dword v247, v249, s[60:63], 0 offen sc1
    s_add_u32 s87, s87, 1
    s_waitcnt vmcnt(0)
    v_and_b32 v247, v242, v247
    v_cmp_ne_u32 vcc, v241, v247
    s_nop 1
    s_cmp_eq_u64 vcc, 0
    s_cbranch_scc1 L_pw850
    s_cmp_lt_u32 s87, 64
    s_cbranch_scc1 L_pl850
    s_lshl_b32 s75, s68, 5
    s_add_u32 s75, s75, s69
    s_mov_b64 exec, 1
    s_and_b32 s3, s75, 3
    s_lshl_b32 s3, s3, 3
    s_or_b32 s4, s71, 64
    s_lshl_b32 s4, s4, s3
    s_and_b32 s3, s75, 0xfc
    v_mov_b32 v250, s3
    v_mov_b32 v247, s4
    buffer_atomic_or v247, v250, s[60:63], 0 offen sc1
    s_mov_b64 exec, 0xff
    v_mov_b32 v247, 0
    buffer_atomic_or v247, v249, s[60:63], 0 offen sc0 sc1
    s_waitcnt vmcnt(0)
    s_or_b32 s3, s71, 64
    s_mul_i32 s3, s3, 16843009
    v_xor_b32 v247, s3, v247
    v_lshrrev_b32 v250, 6, v247
    v_not_b32 v250, v250
    v_lshrrev_b32 v243, 1, v247
    v_or_b32 v243, v243, v247
    v_lshrrev_b32 v247, 2, v247
    v_or_b32 v243, v243, v247
    v_and_b32 v243, v243, v250
    v_and_b32 v243, 0x1010101, v243
    v_cmp_ne_u32 vcc, 0, v243
    s_mov_b64 exec, -1
    s_sleep 8
    s_cmp_eq_u64 vcc, 0
    s_cselect_b32 s6, 0, 1
    s_cbranch_scc0 L_pw850
    s_cmp_lt_u32 s87, 400000
    s_cbranch_scc1 L_pl850
    s_branch L_pw850
L_ps850:
    s_mov_b64 exec, 0xff
    v_mov_b32 v247, 0
    buffer_atomic_or v247, v249, s[60:63], 0 offen sc0 sc1
    s_add_u32 s87, s87, 1
    s_mov_b32 s3, 0x80808080
    s_waitcnt vmcnt(0)
    v_and_b32 v247, s3, v247
    v_cmp_ne_u32 vcc, s3, v247
    s_mov_b64 exec, -1
    s_nop 0
    s_cmp_eq_u64 vcc, 0
    s_cbranch_scc1 L_pw850
    s_sleep 8
    s_cmp_lt_u32 s87, 400000
    s_cbranch_scc1 L_ps850
L_pw850:
    s_add_u32 s6, s6, 1
    v_mov_b32 v250, 163776
    v_mov_b32 v247, s6
    ds_write_b32 v250, v247
L_B6:
    v_and_b32 v6, 15, v1
    v_lshrrev_b32 v7, 4, v1
    v_and_b32 v8, 3, v6
    v_mul_u32_u24 v8, 4160, v8
    v_lshrrev_b32 v9, 2, v6
    v_add_u32 v9, v9, v7
    v_lshlrev_b32 v9, 4, v9
    v_add_u32 v8, v8, v9
    s_mul_i32 s75, s70, 16640
    v_add_u32 v200, s75, v8
    s_lshl_b32 s75, s70, 7
    s_add_u32 s75, s75, 66560
    v_add_u32 v202, s75, v8
    v_and_b32 v8, 1, v6
    v_mul_u32_u24 v8, 4640, v8
    v_lshrrev_b32 v9, 1, v6
    v_lshlrev_b32 v9, 6, v9
    v_sub_u32 v8, v8, v9
    v_lshlrev_b32 v9, 4, v7
    v_add_u32 v8, v8, v9
    v_add_u32 v8, 83664, v8
    s_mul_i32 s75, s70, 9280
    v_add_u32 v201, s75, v8
    s_lshl_b32 s75, s70, 7
    s_add_u32 s75, s75, 37120
    v_add_u32 v203, s75, v8
    v_and_b32 v8, 1, v6
    v_lshlrev_b32 v8, 3, v8
    v_lshrrev_b32 v9, 1, v6
    v_lshlrev_b32 v9, 6, v9
    v_add_u32 v8, v8, v9
    v_lshlrev_b32 v9, 4, v7
    v_add_u32 v248, v8, v9
    v_lshlrev_b32 v246, 4, v1
    s_lshl_b32 s75, s70, 13
    s_add_u32 s75, s75, 129600
    v_add_u32 v246, s75, v246
    v_mul_u32_u24 v3, 1639, v0
    v_lshrrev_b32 v3, 16, v3
    v_mul_u32_u24 v2, 40, v3
    v_sub_u32 v2, v0, v2
    s_lshl_b32 s75, s69, 6
    v_lshlrev_b32 v229, 3, v3
    v_add_u32 v229, s75, v229
    v_mul_u32_u24 v229, 1280, v229
    s_lshl_b32 s75, s73, 1
    v_lshlrev_b32 v228, 3, v2
    v_add3_u32 v229, v229, v228, s75
    v_add_u32 v228, 5120, v229
    s_mov_b32 s48, s22
    s_mov_b32 s49, s23
    s_mul_i32 s50, s72, 2621440
    s_mov_b32 s51, 0x20000
    s_branch L_CV
L_A1:
    v_and_b32 v6, 15, v1
    v_lshlrev_b32 v6, 2, v6
    v_add_u32 v6, 163776, v6
    v_mov_b32 v7, 0
    ds_write_b32 v6, v7
    s_min_u32 s3, s70, 4
    s_mul_i32 s4, s69, 5
    s_add_u32 s4, s4, s73
    s_add_u32 s4, s4, s3
    s_lshl_b32 s75, s4, 8
    s_lshl_b32 s86, s4, 1
    v_lshlrev_b32 v8, 2, v1
    s_add_u32 s4, s10, s75
    s_addc_u32 s5, s11, 0
    s_mov_b32 s6, 256
    s_mov_b32 s7, 0x20000
    buffer_load_dword v26, v8, s[4:7], 0 offen
    s_nop 0
    s_add_u32 s4, s12, s75
    s_addc_u32 s5, s13, 0
    s_mov_b32 s6, 256
    s_mov_b32 s7, 0x20000
    buffer_load_dword v27, v8, s[4:7], 0 offen
    s_nop 0
    s_add_u32 s4, s14, s75
    s_addc_u32 s5, s15, 0
    s_mov_b32 s6, 256
    s_mov_b32 s7, 0x20000
    buffer_load_dword v28, v8, s[4:7], 0 offen
    s_nop 0
    s_add_u32 s4, s16, s75
    s_addc_u32 s5, s17, 0
    s_mov_b32 s6, 256
    s_mov_b32 s7, 0x20000
    buffer_load_dword v29, v8, s[4:7], 0 offen
    s_nop 0
    s_mov_b32 s44, s18
    s_mov_b32 s45, s19
    s_mov_b32 s46, 1280
    s_mov_b32 s47, 0x20000
    s_mov_b32 s48, s20
    s_mov_b32 s49, s21
    s_mov_b32 s50, 1280
    s_mov_b32 s51, 0x20000
    v_mov_b32 v9, s86
    buffer_load_ushort v30, v9, s[44:47], 0 offen
    buffer_load_ushort v255, v9, s[48:51], 0 offen
    s_mul_i32 s75, s68, 655360
    s_add_u32 s52, s38, s75
    s_addc_u32 s53, s39, 0
    s_mov_b32 s54, 655360
    s_mov_b32 s55, 0x20000
    s_mov_b32 s60, s36
    s_mov_b32 s61, s37
    s_mov_b32 s62, 256
    s_mov_b32 s63, 0x20000
    s_mov_b32 s56, s34
    s_mov_b32 s57, s35
    s_mov_b32 s58, 5242880
    s_mov_b32 s59, 0x20000
    s_waitcnt lgkmcnt(0)
    s_barrier
    v_and_b32 v6, 15, v1
    v_lshrrev_b32 v7, 4, v1
    v_and_b32 v8, 3, v6
    v_mul_u32_u24 v8, 4160, v8
    v_lshrrev_b32 v9, 2, v6
    v_add_u32 v9, v9, v7
    v_lshlrev_b32 v9, 4, v9
    v_add_u32 v8, v8, v9
    s_mul_i32 s75, s70, 16640
    v_add_u32 v200, s75, v8
    s_lshl_b32 s75, s70, 7
    s_add_u32 s75, s75, 66560
    v_add_u32 v202, s75, v8
    v_and_b32 v8, 1, v6
    v_mul_u32_u24 v8, 4640, v8
    v_lshrrev_b32 v9, 1, v6
    v_lshlrev_b32 v9, 6, v9
    v_sub_u32 v8, v8, v9
    v_lshlrev_b32 v9, 4, v7
    v_add_u32 v8, v8, v9
    v_add_u32 v8, 83664, v8
    s_mul_i32 s75, s70, 9280
    v_add_u32 v201, s75, v8
    s_lshl_b32 s75, s70, 7
    s_add_u32 s75, s75, 37120
    v_add_u32 v203, s75, v8
    v_and_b32 v8, 1, v6
    v_lshlrev_b32 v8, 3, v8
    v_lshrrev_b32 v9, 1, v6
    v_lshlrev_b32 v9, 6, v9
    v_add_u32 v8, v8, v9
    v_lshlrev_b32 v9, 4, v7
    v_add_u32 v248, v8, v9
    v_lshlrev_b32 v246, 4, v1
    s_lshl_b32 s75, s70, 13
    s_add_u32 s75, s75, 129600
    v_add_u32 v246, s75, v246
    v_mul_u32_u24 v3, 1639, v0
    v_lshrrev_b32 v3, 16, v3
    v_mul_u32_u24 v2, 40, v3
    v_sub_u32 v2, v0, v2
    s_lshl_b32 s75, s69, 6
    v_lshlrev_b32 v229, 3, v3
    v_add_u32 v229, s75, v229
    v_mul_u32_u24 v229, 1280, v229
    s_lshl_b32 s75, s73, 1
    v_lshlrev_b32 v228, 3, v2
    v_add3_u32 v229, v229, v228, s75
    v_add_u32 v228, 5120, v229
    s_mov_b32 s48, s22
    s_mov_b32 s49, s23
    s_mul_i32 s50, s72, 2621440
    s_mov_b32 s51, 0x20000
    s_cmp_eq_u32 s70, 5
    s_cbranch_scc1 L_A5
    s_cmp_ge_u32 s70, 6
    s_cbranch_scc1 L_A6
    s_mul_i32 s4, s70, 16640
    v_and_b32 v6, 15, v1
    v_lshrrev_b32 v7, 4, v1
    v_and_b32 v8, 1, v7
    v_lshlrev_b32 v8, 3, v8
    v_lshrrev_b32 v9, 1, v7
    v_lshlrev_b32 v9, 8, v9
    v_lshlrev_b32 v10, 4, v6
    v_add3_u32 v8, v8, v9, v10
    v_add_u32 v214, s4, v8
    v_lshlrev_b32 v9, 6, v7
    v_lshlrev_b32 v10, 2, v6
    v_add_u32 v10, v10, v9
    v_lshlrev_b32 v11, 1, v6
    v_add_u32 v11, v11, v9
    v_cmp_gt_u32 vcc, 2, v7
    s_nop 1
    v_cndmask_b32 v10, v11, v10, vcc
    v_mov_b32 v11, 128
    v_mov_b32 v12, 8
    v_cndmask_b32 v11, v11, v12, vcc
    v_lshlrev_b32 v10, 2, v10
    v_add_u32 v215, s4, v10
    v_add_u32 v216, v215, v11
    v_add_u32 v12, v9, v6
    v_lshlrev_b32 v12, 2, v12
    v_add_u32 v217, s4, v12
    v_and_b32 v13, 31, v1
    v_lshlrev_b32 v13, 4, v13
    v_add_u32 v218, s4, v13
    v_lshlrev_b32 v13, 3, v1
    v_add_u32 v219, s4, v13
    v_lshlrev_b32 v13, 2, v1
    v_add_u32 v220, s4, v13
    v_lshlrev_b32 v13, 4, v1
    v_add_u32 v221, s4, v13
    s_mul_i32 s75, s70, 16640
    v_lshlrev_b32 v112, 2, v1
    v_add_u32 v112, s75, v112
    v_and_b32 v6, 15, v1
    v_lshrrev_b32 v7, 4, v1
    v_lshlrev_b32 v8, 8, v6
    v_add_u32 v8, s75, v8
    v_or_b32 v9, 0, v7
    v_xor_b32 v9, v9, v6
    v_lshlrev_b32 v9, 4, v9
    v_add_u32 v114, v8, v9
    v_or_b32 v9, 4, v7
    v_xor_b32 v9, v9, v6
    v_lshlrev_b32 v9, 4, v9
    v_add_u32 v115, v8, v9
    v_or_b32 v9, 8, v7
    v_xor_b32 v9, v9, v6
    v_lshlrev_b32 v9, 4, v9
    v_add_u32 v116, v8, v9
    v_or_b32 v9, 12, v7
    v_xor_b32 v9, v9, v6
    v_lshlrev_b32 v9, 4, v9
    v_add_u32 v117, v8, v9
    s_waitcnt vmcnt(0)
    s_cmp_eq_u32 s70, 4
    s_cbranch_scc1 L_A4
    s_mov_b32 s95, 16
    s_mov_b32 s93, 0
    s_call_b64 s[64:65], L_KS
    s_call_b64 s[64:65], L_KV
    s_mov_b32 s95, 0
    s_call_b64 s[64:65], L_KS
    s_waitcnt lgkmcnt(0)
    v_mfma_f32_16x16x32_bf16 v[40:43], v[150:153], v[134:137], 0
    v_mfma_f32_16x16x32_bf16 v[40:43], v[154:157], v[138:141], v[40:43]
    v_mfma_f32_16x16x32_bf16 v[40:43], v[158:161], v[142:145], v[40:43]
    v_mfma_f32_16x16x32_bf16 v[40:43], v[162:165], v[146:149], v[40:43]
    v_mfma_f32_16x16x32_bf16 v[44:47], v[166:169], v[134:137], 0
    v_mfma_f32_16x16x32_bf16 v[44:47], v[170:173], v[138:141], v[44:47]
    v_mfma_f32_16x16x32_bf16 v[44:47], v[174:177], v[142:145], v[44:47]
    v_mfma_f32_16x16x32_bf16 v[44:47], v[178:181], v[146:149], v[44:47]
    v_mfma_f32_16x16x32_bf16 v[48:51], v[182:185], v[134:137], 0
    v_mfma_f32_16x16x32_bf16 v[48:51], v[186:189], v[138:141], v[48:51]
    v_mfma_f32_16x16x32_bf16 v[48:51], v[190:193], v[142:145], v[48:51]
    v_mfma_f32_16x16x32_bf16 v[48:51], v[194:197], v[146:149], v[48:51]
    s_mov_b32 s93, 1
    s_call_b64 s[64:65], L_KV
    s_waitcnt lgkmcnt(8)
    v_mfma_f32_16x16x32_bf16 v[40:43], v[150:153], v[134:137], v[40:43]
    v_mfma_f32_16x16x32_bf16 v[40:43], v[154:157], v[138:141], v[40:43]
    v_mfma_f32_16x16x32_bf16 v[40:43], v[158:161], v[142:145], v[40:43]
    v_mfma_f32_16x16x32_bf16 v[40:43], v[162:165], v[146:149], v[40:43]
    s_waitcnt lgkmcnt(4)
    v_mfma_f32_16x16x32_bf16 v[44:47], v[166:169], v[134:137], v[44:47]
    v_mfma_f32_16x16x32_bf16 v[44:47], v[170:173], v[138:141], v[44:47]
    v_mfma_f32_16x16x32_bf16 v[44:47], v[174:177], v[142:145], v[44:47]
    v_mfma_f32_16x16x32_bf16 v[44:47], v[178:181], v[146:149], v[44:47]
    s_waitcnt lgkmcnt(0)
    v_mfma_f32_16x16x32_bf16 v[48:51], v[182:185], v[134:137], v[48:51]
    v_mfma_f32_16x16x32_bf16 v[48:51], v[186:189], v[138:141], v[48:51]
    v_mfma_f32_16x16x32_bf16 v[48:51], v[190:193], v[142:145], v[48:51]
    v_mfma_f32_16x16x32_bf16 v[48:51], v[194:197], v[146:149], v[48:51]
    s_nop 7
    s_branch L_A4b
L_A4:
    v_mov_b32 v250, 163780
    s_mov_b32 s4, 0
L_go1205:
    ds_read_b32 v247, v250
    s_add_u32 s4, s4, 1
    s_waitcnt lgkmcnt(0)
    v_readfirstlane_b32 s3, v247
    s_cmp_ge_u32 s4, 0x1000000
    s_cbranch_scc1 L_gx1205
    s_cmp_lt_u32 s3, 2
    s_cbranch_scc0 L_gx1205
    s_sleep 1
    s_branch L_go1205
L_gx1205:
    s_setprio 2
    v_lshlrev_b32 v6, 4, v1
    v_add_u32 v6, 146176, v6
    ds_read_b128 v[100:103], v6 offset:0
    ds_read_b128 v[104:107], v6 offset:1024
    ds_read_b128 v[108:111], v6 offset:2048
    ds_read_b128 v[112:115], v6 offset:3072
    ds_read_b128 v[116:119], v6 offset:4096
    ds_read_b128 v[120:123], v6 offset:5120
    s_waitcnt lgkmcnt(0)
    v_add_f32 v40, v100, v112
    v_add_f32 v41, v101, v113
    v_add_f32 v42, v102, v114
    v_add_f32 v43, v103, v115
    v_add_f32 v44, v104, v116
    v_add_f32 v45, v105, v117
    v_add_f32 v46, v106, v118
    v_add_f32 v47, v107, v119
    v_add_f32 v48, v108, v120
    v_add_f32 v49, v109, v121
    v_add_f32 v50, v110, v122
    v_add_f32 v51, v111, v123
L_A4b:
    s_mul_i32 s4, s70, 16640
    s_mov_b32 s3, 0xffff
    v_lshlrev_b32 v13, 16, v255
    s_mov_b64 exec, 1
    v_add_f32 v40, v40, v13
    s_mov_b64 exec, -1
    v_cvt_pk_bf16_f32 v14, v40, v41
    v_cvt_pk_bf16_f32 v15, v42, v43
    v_cvt_pk_bf16_f32 v16, v44, v44
    v_cvt_pk_bf16_f32 v17, v45, v45
    v_cvt_pk_bf16_f32 v18, v46, v46
    v_cvt_pk_bf16_f32 v19, v47, v47
    v_cvt_pk_bf16_f32 v20, v48, v48
    v_cvt_pk_bf16_f32 v21, v49, v49
    v_cvt_pk_bf16_f32 v22, v50, v50
    v_cvt_pk_bf16_f32 v23, v51, v51
    ds_write_b64 v215, v[16:17] offset:4112
    ds_write_b64 v216, v[18:19] offset:4112
    ds_write_b32 v217, v20 offset:5136
    ds_write_b32 v217, v21 offset:5200
    ds_write_b32 v217, v22 offset:5264
    ds_write_b32 v217, v23 offset:5328
    ds_write_b64 v214, v[14:15]
    v_and_b32 v13, 1, v1
    v_cmp_eq_u32 vcc, 1, v13
    s_waitcnt lgkmcnt(0)
    ds_read_b128 v[32:35], v218 offset:4112
    ds_read_b32 v36, v218 offset:4128
    ds_read_b64 v[60:61], v219 offset:4624
    ds_read_b32 v62, v219 offset:4632
    ds_read_b32 v64, v220 offset:5136
    ds_read_b32 v65, v220 offset:5140
    ds_read_b32 v66, v220 offset:5392
    ds_read_b32 v67, v220 offset:5396
    s_waitcnt lgkmcnt(0)
    v_bfi_b32 v33, s3, v33, v34
    v_bfi_b32 v35, s3, v35, v36
    v_mov_b32 v68, v60
    v_bfi_b32 v69, s3, v60, v61
    v_mov_b32 v70, v61
    v_mov_b32 v71, v62
    ds_write_b128 v218, v[32:35] offset:512
    ds_write_b128 v221, v[68:71] offset:1024
    v_mov_b32 v72, v64
    v_mov_b32 v73, v64
    v_cndmask_b32 v74, v64, v65, vcc
    v_bfi_b32 v74, s3, v74, v65
    v_mov_b32 v75, v65
    v_mov_b32 v76, v66
    v_mov_b32 v77, v66
    v_cndmask_b32 v78, v66, v67, vcc
    v_bfi_b32 v78, s3, v78, v67
    v_mov_b32 v79, v67
    ds_write_b128 v221, v[72:75] offset:2048
    ds_write_b128 v221, v[76:79] offset:3072
    s_waitcnt lgkmcnt(0)
    ds_read_b32 v100, v220 offset:0
    ds_read_b32 v101, v220 offset:256
    ds_read_b32 v102, v220 offset:512
    ds_read_b32 v103, v220 offset:768
    ds_read_b32 v104, v220 offset:1024
    ds_read_b32 v105, v220 offset:1280
    ds_read_b32 v106, v220 offset:1536
    ds_read_b32 v107, v220 offset:1792
    ds_read_b32 v108, v220 offset:2048
    ds_read_b32 v109, v220 offset:2304
    ds_read_b32 v110, v220 offset:2560
    ds_read_b32 v111, v220 offset:2816
    ds_read_b32 v112, v220 offset:3072
    ds_read_b32 v113, v220 offset:3328
    ds_read_b32 v114, v220 offset:3584
    ds_read_b32 v115, v220 offset:3840
    s_waitcnt lgkmcnt(8)
    ds_read_b32 v116, v220 offset:4
    ds_read_b32 v117, v220 offset:260
    ds_read_b32 v118, v220 offset:516
    ds_read_b32 v119, v220 offset:772
    ds_read_b32 v120, v220 offset:1028
    ds_read_b32 v121, v220 offset:1284
    ds_read_b32 v122, v220 offset:1540
    ds_read_b32 v123, v220 offset:1796
    ds_read_b32 v124, v220 offset:2052
    ds_read_b32 v125, v220 offset:2308
    ds_read_b32 v126, v220 offset:2564
    ds_read_b32 v127, v220 offset:2820
    ds_read_b32 v128, v220 offset:3076
    ds_read_b32 v129, v220 offset:3332
    ds_read_b32 v130, v220 offset:3588
    ds_read_b32 v131, v220 offset:3844
    s_waitcnt lgkmcnt(0)
    s_mul_i32 s75, s70, 16640
    s_mov_b32 m0, s75
    v_readlane_b32 s3, v100, 0
    v_lshlrev_b32 v6, 2, v1
    v_add_u32 v6, s75, v6
    s_lshl_b32 s3, s3, 16
    v_mov_b32 v7, 0
    v_mov_b32 v244, s3
    v_cmp_eq_u32 vcc, 13, v1
    s_nop 1
    v_cndmask_b32 v245, v7, v244, vcc
    v_cmp_eq_u32 vcc, 12, v1
    s_nop 1
    v_cndmask_b32 v244, v7, v244, vcc
    s_mov_b64 exec, 0x3fff
    ds_write_b32 v6, v245
    ds_write_b32 v6, v7 offset:4160
    ds_write_b32 v6, v244 offset:8320
    s_mov_b64 exec, 0xfff
    ds_write_b32 v6, v7 offset:12480
    s_mov_b64 exec, -1
    ds_write_addtid_b32 v100 offset:4212
    v_alignbit_b32 v116, v116, v100, 16
    ds_write_addtid_b32 v101 offset:4468
    v_alignbit_b32 v117, v117, v101, 16
    ds_write_addtid_b32 v102 offset:4724
    v_alignbit_b32 v118, v118, v102, 16
    ds_write_addtid_b32 v103 offset:4980
    v_alignbit_b32 v119, v119, v103, 16
    ds_write_addtid_b32 v104 offset:5236
    v_alignbit_b32 v120, v120, v104, 16
    ds_write_addtid_b32 v105 offset:5492
    v_alignbit_b32 v121, v121, v105, 16
    ds_write_addtid_b32 v106 offset:5748
    v_alignbit_b32 v122, v122, v106, 16
    ds_write_addtid_b32 v107 offset:6004
    v_alignbit_b32 v123, v123, v107, 16
    ds_write_addtid_b32 v108 offset:6260
    v_alignbit_b32 v124, v124, v108, 16
    ds_write_addtid_b32 v109 offset:6516
    v_alignbit_b32 v125, v125, v109, 16
    ds_write_addtid_b32 v110 offset:6772
    v_alignbit_b32 v126, v126, v110, 16
    ds_write_addtid_b32 v111 offset:7028
    v_alignbit_b32 v127, v127, v111, 16
    ds_write_addtid_b32 v112 offset:7284
    v_alignbit_b32 v128, v128, v112, 16
    ds_write_addtid_b32 v113 offset:7540
    v_alignbit_b32 v129, v129, v113, 16
    ds_write_addtid_b32 v114 offset:7796
    v_alignbit_b32 v130, v130, v114, 16
    ds_write_addtid_b32 v115 offset:8052
    v_alignbit_b32 v131, v131, v115, 16
    ds_write_addtid_b32 v100 offset:12528
    ds_write_addtid_b32 v101 offset:12784
    ds_write_addtid_b32 v102 offset:13040
    ds_write_addtid_b32 v103 offset:13296
    ds_write_addtid_b32 v104 offset:13552
    ds_write_addtid_b32 v105 offset:13808
    ds_write_addtid_b32 v106 offset:14064
    ds_write_addtid_b32 v107 offset:14320
    ds_write_addtid_b32 v108 offset:14576
    ds_write_addtid_b32 v109 offset:14832
    ds_write_addtid_b32 v110 offset:15088
    ds_write_addtid_b32 v111 offset:15344
    ds_write_addtid_b32 v112 offset:15600
    ds_write_addtid_b32 v113 offset:15856
    ds_write_addtid_b32 v114 offset:16112
    ds_write_addtid_b32 v115 offset:16368
    ds_write_addtid_b32 v116 offset:56
    ds_write_addtid_b32 v116 offset:8372
    ds_write_addtid_b32 v117 offset:312
    ds_write_addtid_b32 v117 offset:8628
    ds_write_addtid_b32 v118 offset:568
    ds_write_addtid_b32 v118 offset:8884
    ds_write_addtid_b32 v119 offset:824
    ds_write_addtid_b32 v119 offset:9140
    ds_write_addtid_b32 v120 offset:1080
    ds_write_addtid_b32 v120 offset:9396
    ds_write_addtid_b32 v121 offset:1336
    ds_write_addtid_b32 v121 offset:9652
    ds_write_addtid_b32 v122 offset:1592
    ds_write_addtid_b32 v122 offset:9908
    ds_write_addtid_b32 v123 offset:1848
    ds_write_addtid_b32 v123 offset:10164
    ds_write_addtid_b32 v124 offset:2104
    ds_write_addtid_b32 v124 offset:10420
    ds_write_addtid_b32 v125 offset:2360
    ds_write_addtid_b32 v125 offset:10676
    ds_write_addtid_b32 v126 offset:2616
    ds_write_addtid_b32 v126 offset:10932
    ds_write_addtid_b32 v127 offset:2872
    ds_write_addtid_b32 v127 offset:11188
    ds_write_addtid_b32 v128 offset:3128
    ds_write_addtid_b32 v128 offset:11444
    ds_write_addtid_b32 v129 offset:3384
    ds_write_addtid_b32 v129 offset:11700
    ds_write_addtid_b32 v130 offset:3640
    ds_write_addtid_b32 v130 offset:11956
    ds_write_addtid_b32 v131 offset:3896
    ds_write_addtid_b32 v131 offset:12212
    s_cmp_lg_u32 s70, 4
    s_cbranch_scc0 L_A4c
    v_mov_b32 v250, 163776
    s_mov_b32 s4, 0
L_ud1433:
    ds_read2_b32 v[244:245], v250 offset0:0 offset1:7
    s_add_u32 s4, s4, 1
    s_waitcnt lgkmcnt(0)
    v_readfirstlane_b32 s5, v245
    v_readfirstlane_b32 s3, v244
    s_cmp_ge_u32 s4, 0x1000000
    s_cbranch_scc1 L_CV
    s_cmp_ge_u32 s5, 2
    s_cbranch_scc1 L_CVK
    s_sleep 1
    s_branch L_ud1433
L_A4c:
    s_waitcnt lgkmcnt(0)
    v_mov_b32 v250, 163796
    v_mov_b32 v247, 1
    s_mov_b64 exec, 1
    ds_add_u32 v250, v247
    s_mov_b64 exec, -1
    s_branch L_CV
L_A5:
    s_setprio 3
    s_lshl_b32 s75, s68, 5
    s_lshl_b32 s3, s92, 30
    s_add_u32 s75, s75, s3
    v_mov_b32 v8, s75
    buffer_load_dword v252, v8, s[60:63], 0 offen
    s_mov_b32 s40, s8
    s_mov_b32 s41, s9
    s_mov_b32 s42, 2621440
    s_mov_b32 s43, 0x20000
    v_add_u32 v238, 0, v1
    v_mul_u32_u24 v3, 1639, v238
    v_lshrrev_b32 v3, 16, v3
    v_mul_u32_u24 v2, 40, v3
    v_sub_u32 v2, v238, v2
    s_lshl_b32 s75, s69, 6
    v_lshlrev_b32 v4, 3, v3
    v_add_u32 v4, s75, v4
    v_mul_u32_u24 v4, 1280, v4
    s_lshl_b32 s75, s73, 1
    v_lshlrev_b32 v5, 3, v2
    v_add3_u32 v4, v4, v5, s75
    v_add_u32 v5, 5120, v4
    buffer_load_dwordx2 v[134:135], v4, s[40:43], 0 offen offset:0
    buffer_load_dwordx2 v[136:137], v4, s[40:43], 0 offen offset:1280
    buffer_load_dwordx2 v[138:139], v4, s[40:43], 0 offen offset:2560
    buffer_load_dwordx2 v[140:141], v4, s[40:43], 0 offen offset:3840
    buffer_load_dwordx2 v[142:143], v5, s[40:43], 0 offen offset:0
    buffer_load_dwordx2 v[144:145], v5, s[40:43], 0 offen offset:1280
    buffer_load_dwordx2 v[146:147], v5, s[40:43], 0 offen offset:2560
    buffer_load_dwordx2 v[148:149], v5, s[40:43], 0 offen offset:3840
    v_sub_u32 v6, 7, v3
    v_and_b32 v7, 7, v2
    v_xor_b32 v6, v6, v7
    v_lshlrev_b32 v6, 4, v6
    v_lshlrev_b32 v7, 9, v2
    v_add_u32 v7, 83200, v7
    v_add_u32 v230, v6, v7
    v_add_u32 v238, 64, v1
    v_mul_u32_u24 v3, 1639, v238
    v_lshrrev_b32 v3, 16, v3
    v_mul_u32_u24 v2, 40, v3
    v_sub_u32 v2, v238, v2
    s_lshl_b32 s75, s69, 6
    v_lshlrev_b32 v4, 3, v3
    v_add_u32 v4, s75, v4
    v_mul_u32_u24 v4, 1280, v4
    s_lshl_b32 s75, s73, 1
    v_lshlrev_b32 v5, 3, v2
    v_add3_u32 v4, v4, v5, s75
    v_add_u32 v5, 5120, v4
    buffer_load_dwordx2 v[150:151], v4, s[40:43], 0 offen offset:0
    buffer_load_dwordx2 v[152:153], v4, s[40:43], 0 offen offset:1280
    buffer_load_dwordx2 v[154:155], v4, s[40:43], 0 offen offset:2560
    buffer_load_dwordx2 v[156:157], v4, s[40:43], 0 offen offset:3840
    buffer_load_dwordx2 v[158:159], v5, s[40:43], 0 offen offset:0
    buffer_load_dwordx2 v[160:161], v5, s[40:43], 0 offen offset:1280
    buffer_load_dwordx2 v[162:163], v5, s[40:43], 0 offen offset:2560
    buffer_load_dwordx2 v[164:165], v5, s[40:43], 0 offen offset:3840
    v_sub_u32 v6, 7, v3
    v_and_b32 v7, 7, v2
    v_xor_b32 v6, v6, v7
    v_lshlrev_b32 v6, 4, v6
    v_lshlrev_b32 v7, 9, v2
    v_add_u32 v7, 83200, v7
    v_add_u32 v231, v6, v7
    v_add_u32 v238, 128, v1
    v_mul_u32_u24 v3, 1639, v238
    v_lshrrev_b32 v3, 16, v3
    v_mul_u32_u24 v2, 40, v3
    v_sub_u32 v2, v238, v2
    s_lshl_b32 s75, s69, 6
    v_lshlrev_b32 v4, 3, v3
    v_add_u32 v4, s75, v4
    v_mul_u32_u24 v4, 1280, v4
    s_lshl_b32 s75, s73, 1
    v_lshlrev_b32 v5, 3, v2
    v_add3_u32 v4, v4, v5, s75
    v_add_u32 v5, 5120, v4
    buffer_load_dwordx2 v[166:167], v4, s[40:43], 0 offen offset:0
    buffer_load_dwordx2 v[168:169], v4, s[40:43], 0 offen offset:1280
    buffer_load_dwordx2 v[170:171], v4, s[40:43], 0 offen offset:2560
    buffer_load_dwordx2 v[172:173], v4, s[40:43], 0 offen offset:3840
    buffer_load_dwordx2 v[174:175], v5, s[40:43], 0 offen offset:0
    buffer_load_dwordx2 v[176:177], v5, s[40:43], 0 offen offset:1280
    buffer_load_dwordx2 v[178:179], v5, s[40:43], 0 offen offset:2560
    buffer_load_dwordx2 v[180:181], v5, s[40:43], 0 offen offset:3840
    v_sub_u32 v6, 7, v3
    v_and_b32 v7, 7, v2
    v_xor_b32 v6, v6, v7
    v_lshlrev_b32 v6, 4, v6
    v_lshlrev_b32 v7, 9, v2
    v_add_u32 v7, 83200, v7
    v_add_u32 v232, v6, v7
    v_add_u32 v238, 192, v1
    v_mul_u32_u24 v3, 1639, v238
    v_lshrrev_b32 v3, 16, v3
    v_mul_u32_u24 v2, 40, v3
    v_sub_u32 v2, v238, v2
    s_lshl_b32 s75, s69, 6
    v_lshlrev_b32 v4, 3, v3
    v_add_u32 v4, s75, v4
    v_mul_u32_u24 v4, 1280, v4
    s_lshl_b32 s75, s73, 1
    v_lshlrev_b32 v5, 3, v2
    v_add3_u32 v4, v4, v5, s75
    v_add_u32 v5, 5120, v4
    buffer_load_dwordx2 v[182:183], v4, s[40:43], 0 offen offset:0
    buffer_load_dwordx2 v[184:185], v4, s[40:43], 0 offen offset:1280
    buffer_load_dwordx2 v[186:187], v4, s[40:43], 0 offen offset:2560
    buffer_load_dwordx2 v[188:189], v4, s[40:43], 0 offen offset:3840
    buffer_load_dwordx2 v[190:191], v5, s[40:43], 0 offen offset:0
    buffer_load_dwordx2 v[192:193], v5, s[40:43], 0 offen offset:1280
    buffer_load_dwordx2 v[194:195], v5, s[40:43], 0 offen offset:2560
    buffer_load_dwordx2 v[196:197], v5, s[40:43], 0 offen offset:3840
    v_sub_u32 v6, 7, v3
    v_and_b32 v7, 7, v2
    v_xor_b32 v6, v6, v7
    v_lshlrev_b32 v6, 4, v6
    v_lshlrev_b32 v7, 9, v2
    v_add_u32 v7, 83200, v7
    v_add_u32 v233, v6, v7
    v_add_u32 v238, 256, v1
    v_mul_u32_u24 v3, 1639, v238
    v_lshrrev_b32 v3, 16, v3
    v_mul_u32_u24 v2, 40, v3
    v_sub_u32 v2, v238, v2
    s_lshl_b32 s75, s69, 6
    v_lshlrev_b32 v4, 3, v3
    v_add_u32 v4, s75, v4
    v_mul_u32_u24 v4, 1280, v4
    s_lshl_b32 s75, s73, 1
    v_lshlrev_b32 v5, 3, v2
    v_add3_u32 v4, v4, v5, s75
    v_add_u32 v5, 5120, v4
    buffer_load_dwordx2 v[198:199], v4, s[40:43], 0 offen offset:0
    buffer_load_dwordx2 v[200:201], v4, s[40:43], 0 offen offset:1280
    buffer_load_dwordx2 v[202:203], v4, s[40:43], 0 offen offset:2560
    buffer_load_dwordx2 v[204:205], v4, s[40:43], 0 offen offset:3840
    buffer_load_dwordx2 v[206:207], v5, s[40:43], 0 offen offset:0
    buffer_load_dwordx2 v[208:209], v5, s[40:43], 0 offen offset:1280
    buffer_load_dwordx2 v[210:211], v5, s[40:43], 0 offen offset:2560
    buffer_load_dwordx2 v[212:213], v5, s[40:43], 0 offen offset:3840
    v_sub_u32 v6, 7, v3
    v_and_b32 v7, 7, v2
    v_xor_b32 v6, v6, v7
    v_lshlrev_b32 v6, 4, v6
    v_lshlrev_b32 v7, 9, v2
    v_add_u32 v7, 83200, v7
    v_add_u32 v234, v6, v7
    s_waitcnt vmcnt(32)
    v_perm_b32 v108, v146, v148, s77
    v_perm_b32 v109, v142, v144, s77
    v_perm_b32 v110, v138, v140, s77
    v_perm_b32 v111, v134, v136, s77
    ds_write_b128 v230, v[108:111] offset:0
    v_perm_b32 v112, v146, v148, s78
    v_perm_b32 v113, v142, v144, s78
    v_perm_b32 v114, v138, v140, s78
    v_perm_b32 v115, v134, v136, s78
    ds_write_b128 v230, v[112:115] offset:128
    v_perm_b32 v116, v147, v149, s77
    v_perm_b32 v117, v143, v145, s77
    v_perm_b32 v118, v139, v141, s77
    v_perm_b32 v119, v135, v137, s77
    ds_write_b128 v230, v[116:119] offset:256
    v_perm_b32 v120, v147, v149, s78
    v_perm_b32 v121, v143, v145, s78
    v_perm_b32 v122, v139, v141, s78
    v_perm_b32 v123, v135, v137, s78
    ds_write_b128 v230, v[120:123] offset:384
    s_waitcnt vmcnt(24)
    v_perm_b32 v108, v162, v164, s77
    v_perm_b32 v109, v158, v160, s77
    v_perm_b32 v110, v154, v156, s77
    v_perm_b32 v111, v150, v152, s77
    ds_write_b128 v231, v[108:111] offset:0
    v_perm_b32 v112, v162, v164, s78
    v_perm_b32 v113, v158, v160, s78
    v_perm_b32 v114, v154, v156, s78
    v_perm_b32 v115, v150, v152, s78
    ds_write_b128 v231, v[112:115] offset:128
    v_perm_b32 v116, v163, v165, s77
    v_perm_b32 v117, v159, v161, s77
    v_perm_b32 v118, v155, v157, s77
    v_perm_b32 v119, v151, v153, s77
    ds_write_b128 v231, v[116:119] offset:256
    v_perm_b32 v120, v163, v165, s78
    v_perm_b32 v121, v159, v161, s78
    v_perm_b32 v122, v155, v157, s78
    v_perm_b32 v123, v151, v153, s78
    ds_write_b128 v231, v[120:123] offset:384
    s_waitcnt vmcnt(16)
    v_perm_b32 v108, v178, v180, s77
    v_perm_b32 v109, v174, v176, s77
    v_perm_b32 v110, v170, v172, s77
    v_perm_b32 v111, v166, v168, s77
    ds_write_b128 v232, v[108:111] offset:0
    v_perm_b32 v112, v178, v180, s78
    v_perm_b32 v113, v174, v176, s78
    v_perm_b32 v114, v170, v172, s78
    v_perm_b32 v115, v166, v168, s78
    ds_write_b128 v232, v[112:115] offset:128
    v_perm_b32 v116, v179, v181, s77
    v_perm_b32 v117, v175, v177, s77
    v_perm_b32 v118, v171, v173, s77
    v_perm_b32 v119, v167, v169, s77
    ds_write_b128 v232, v[116:119] offset:256
    v_perm_b32 v120, v179, v181, s78
    v_perm_b32 v121, v175, v177, s78
    v_perm_b32 v122, v171, v173, s78
    v_perm_b32 v123, v167, v169, s78
    ds_write_b128 v232, v[120:123] offset:384
    s_waitcnt vmcnt(8)
    v_perm_b32 v108, v194, v196, s77
    v_perm_b32 v109, v190, v192, s77
    v_perm_b32 v110, v186, v188, s77
    v_perm_b32 v111, v182, v184, s77
    ds_write_b128 v233, v[108:111] offset:0
    v_perm_b32 v112, v194, v196, s78
    v_perm_b32 v113, v190, v192, s78
    v_perm_b32 v114, v186, v188, s78
    v_perm_b32 v115, v182, v184, s78
    ds_write_b128 v233, v[112:115] offset:128
    v_perm_b32 v116, v195, v197, s77
    v_perm_b32 v117, v191, v193, s77
    v_perm_b32 v118, v187, v189, s77
    v_perm_b32 v119, v183, v185, s77
    ds_write_b128 v233, v[116:119] offset:256
    v_perm_b32 v120, v195, v197, s78
    v_perm_b32 v121, v191, v193, s78
    v_perm_b32 v122, v187, v189, s78
    v_perm_b32 v123, v183, v185, s78
    ds_write_b128 v233, v[120:123] offset:384
    s_waitcnt vmcnt(0)
    v_perm_b32 v108, v210, v212, s77
    v_perm_b32 v109, v206, v208, s77
    v_perm_b32 v110, v202, v204, s77
    v_perm_b32 v111, v198, v200, s77
    ds_write_b128 v234, v[108:111] offset:0
    v_perm_b32 v112, v210, v212, s78
    v_perm_b32 v113, v206, v208, s78
    v_perm_b32 v114, v202, v204, s78
    v_perm_b32 v115, v198, v200, s78
    ds_write_b128 v234, v[112:115] offset:128
    v_perm_b32 v116, v211, v213, s77
    v_perm_b32 v117, v207, v209, s77
    v_perm_b32 v118, v203, v205, s77
    v_perm_b32 v119, v199, v201, s77
    ds_write_b128 v234, v[116:119] offset:256
    v_perm_b32 v120, v211, v213, s78
    v_perm_b32 v121, v207, v209, s78
    v_perm_b32 v122, v203, v205, s78
    v_perm_b32 v123, v199, v201, s78
    ds_write_b128 v234, v[120:123] offset:384
    v_lshrrev_b32 v6, 3, v1
    v_and_b32 v7, 7, v1
    v_lshrrev_b32 v8, 5, v1
    v_lshlrev_b32 v9, 7, v6
    v_add_u32 v9, 83200, v9
    v_add_u32 v92, 0, v8
    v_and_b32 v92, 7, v92
    v_xor_b32 v92, v92, v7
    v_lshlrev_b32 v92, 4, v92
    v_add_u32 v240, v9, v92
    v_add_u32 v92, 2, v8
    v_and_b32 v92, 7, v92
    v_xor_b32 v92, v92, v7
    v_lshlrev_b32 v92, 4, v92
    v_add_u32 v241, v9, v92
    v_add_u32 v92, 4, v8
    v_and_b32 v92, 7, v92
    v_xor_b32 v92, v92, v7
    v_lshlrev_b32 v92, 4, v92
    v_add_u32 v242, v9, v92
    v_add_u32 v92, 6, v8
    v_and_b32 v92, 7, v92
    v_xor_b32 v92, v92, v7
    v_lshlrev_b32 v92, 4, v92
    v_add_u32 v243, v9, v92
    s_sub_u32 s75, 31, s69
    s_lshl_b32 s75, s75, 7
    v_lshlrev_b32 v6, 12, v6
    v_lshlrev_b32 v7, 4, v7
    v_add3_u32 v237, v6, v7, s75
    ds_read_b128 v[134:137], v240 offset:0
    ds_read_b128 v[138:141], v241 offset:1024
    ds_read_b128 v[142:145], v242 offset:2048
    ds_read_b128 v[146:149], v243 offset:3072
    ds_read_b128 v[150:153], v240 offset:4096
    ds_read_b128 v[154:157], v241 offset:5120
    ds_read_b128 v[158:161], v242 offset:6144
    ds_read_b128 v[162:165], v243 offset:7168
    ds_read_b128 v[166:169], v240 offset:8192
    ds_read_b128 v[170:173], v241 offset:9216
    s_mov_b32 s3, 0
    s_waitcnt lgkmcnt(9)
    buffer_store_dwordx4 v[134:137], v237, s[52:55], s3 offen
    s_mov_b32 s3, 32768
    s_waitcnt lgkmcnt(8)
    buffer_store_dwordx4 v[138:141], v237, s[52:55], s3 offen
    s_mov_b32 s3, 65536
    s_waitcnt lgkmcnt(7)
    buffer_store_dwordx4 v[142:145], v237, s[52:55], s3 offen
    s_mov_b32 s3, 98304
    s_waitcnt lgkmcnt(6)
    buffer_store_dwordx4 v[146:149], v237, s[52:55], s3 offen
    s_mov_b32 s3, 131072
    s_waitcnt lgkmcnt(5)
    buffer_store_dwordx4 v[150:153], v237, s[52:55], s3 offen
    s_mov_b32 s3, 163840
    s_waitcnt lgkmcnt(4)
    buffer_store_dwordx4 v[154:157], v237, s[52:55], s3 offen
    s_mov_b32 s3, 196608
    s_waitcnt lgkmcnt(3)
    buffer_store_dwordx4 v[158:161], v237, s[52:55], s3 offen
    s_mov_b32 s3, 229376
    s_waitcnt lgkmcnt(2)
    buffer_store_dwordx4 v[162:165], v237, s[52:55], s3 offen
    s_mov_b32 s3, 262144
    s_waitcnt lgkmcnt(1)
    buffer_store_dwordx4 v[166:169], v237, s[52:55], s3 offen
    s_mov_b32 s3, 294912
    s_waitcnt lgkmcnt(0)
    buffer_store_dwordx4 v[170:173], v237, s[52:55], s3 offen
    ds_read_b128 v[174:177], v242 offset:10240
    ds_read_b128 v[178:181], v243 offset:11264
    ds_read_b128 v[182:185], v240 offset:12288
    ds_read_b128 v[186:189], v241 offset:13312
    ds_read_b128 v[190:193], v242 offset:14336
    ds_read_b128 v[194:197], v243 offset:15360
    ds_read_b128 v[198:201], v240 offset:16384
    ds_read_b128 v[202:205], v241 offset:17408
    ds_read_b128 v[206:209], v242 offset:18432
    ds_read_b128 v[210:213], v243 offset:19456
    s_mov_b32 s3, 327680
    s_waitcnt lgkmcnt(9)
    buffer_store_dwordx4 v[174:177], v237, s[52:55], s3 offen
    s_mov_b32 s3, 360448
    s_waitcnt lgkmcnt(8)
    buffer_store_dwordx4 v[178:181], v237, s[52:55], s3 offen
    s_mov_b32 s3, 393216
    s_waitcnt lgkmcnt(7)
    buffer_store_dwordx4 v[182:185], v237, s[52:55], s3 offen
    s_mov_b32 s3, 425984
    s_waitcnt lgkmcnt(6)
    buffer_store_dwordx4 v[186:189], v237, s[52:55], s3 offen
    s_mov_b32 s3, 458752
    s_waitcnt lgkmcnt(5)
    buffer_store_dwordx4 v[190:193], v237, s[52:55], s3 offen
    s_mov_b32 s3, 491520
    s_waitcnt lgkmcnt(4)
    buffer_store_dwordx4 v[194:197], v237, s[52:55], s3 offen
    s_mov_b32 s3, 524288
    s_waitcnt lgkmcnt(3)
    buffer_store_dwordx4 v[198:201], v237, s[52:55], s3 offen
    s_mov_b32 s3, 557056
    s_waitcnt lgkmcnt(2)
    buffer_store_dwordx4 v[202:205], v237, s[52:55], s3 offen
    s_mov_b32 s3, 589824
    s_waitcnt lgkmcnt(1)
    buffer_store_dwordx4 v[206:209], v237, s[52:55], s3 offen
    s_mov_b32 s3, 622592
    s_waitcnt lgkmcnt(0)
    buffer_store_dwordx4 v[210:213], v237, s[52:55], s3 offen
    s_cmp_eq_u32 s92, 0
    s_cbranch_scc1 L_us1821
    s_mov_b32 s3, 0
    buffer_store_dwordx4 v[134:137], v237, s[52:55], s3 offen sc1
    s_mov_b32 s3, 32768
    buffer_store_dwordx4 v[138:141], v237, s[52:55], s3 offen sc1
    s_mov_b32 s3, 65536
    buffer_store_dwordx4 v[142:145], v237, s[52:55], s3 offen sc1
    s_mov_b32 s3, 98304
    buffer_store_dwordx4 v[146:149], v237, s[52:55], s3 offen sc1
    s_mov_b32 s3, 131072
    buffer_store_dwordx4 v[150:153], v237, s[52:55], s3 offen sc1
    s_mov_b32 s3, 163840
    buffer_store_dwordx4 v[154:157], v237, s[52:55], s3 offen sc1
    s_mov_b32 s3, 196608
    buffer_store_dwordx4 v[158:161], v237, s[52:55], s3 offen sc1
    s_mov_b32 s3, 229376
    buffer_store_dwordx4 v[162:165], v237, s[52:55], s3 offen sc1
    s_mov_b32 s3, 262144
    buffer_store_dwordx4 v[166:169], v237, s[52:55], s3 offen sc1
    s_mov_b32 s3, 294912
    buffer_store_dwordx4 v[170:173], v237, s[52:55], s3 offen sc1
    s_mov_b32 s3, 327680
    buffer_store_dwordx4 v[174:177], v237, s[52:55], s3 offen sc1
    s_mov_b32 s3, 360448
    buffer_store_dwordx4 v[178:181], v237, s[52:55], s3 offen sc1
    s_mov_b32 s3, 393216
    buffer_store_dwordx4 v[182:185], v237, s[52:55], s3 offen sc1
    s_mov_b32 s3, 425984
    buffer_store_dwordx4 v[186:189], v237, s[52:55], s3 offen sc1
    s_mov_b32 s3, 458752
    buffer_store_dwordx4 v[190:193], v237, s[52:55], s3 offen sc1
    s_mov_b32 s3, 491520
    buffer_store_dwordx4 v[194:197], v237, s[52:55], s3 offen sc1
    s_mov_b32 s3, 524288
    buffer_store_dwordx4 v[198:201], v237, s[52:55], s3 offen sc1
    s_mov_b32 s3, 557056
    buffer_store_dwordx4 v[202:205], v237, s[52:55], s3 offen sc1
    s_mov_b32 s3, 589824
    buffer_store_dwordx4 v[206:209], v237, s[52:55], s3 offen sc1
    s_mov_b32 s3, 622592
    buffer_store_dwordx4 v[210:213], v237, s[52:55], s3 offen sc1
    s_waitcnt vmcnt(0)
L_us1821:
    v_add_u32 v238, 0, v1
    s_sub_u32 s4, 31, s69
    s_lshl_b32 s4, s4, 7
    s_lshl_b32 s3, s92, 30
    s_add_u32 s4, s4, s3
    v_lshlrev_b32 v9, 12, v238
    v_add_u32 v9, s4, v9
    buffer_load_dword v251, v9, s[52:55], 0 offen
    v_add_u32 v238, 64, v1
    s_sub_u32 s4, 31, s69
    s_lshl_b32 s4, s4, 7
    s_lshl_b32 s3, s92, 30
    s_add_u32 s4, s4, s3
    v_lshlrev_b32 v9, 12, v238
    v_add_u32 v9, s4, v9
    buffer_load_dword v251, v9, s[52:55], 0 offen
    v_add_u32 v238, 128, v1
    s_sub_u32 s4, 31, s69
    s_lshl_b32 s4, s4, 7
    s_lshl_b32 s3, s92, 30
    s_add_u32 s4, s4, s3
    v_lshlrev_b32 v9, 12, v238
    v_add_u32 v9, s4, v9
    buffer_load_dword v251, v9, s[52:55], 0 offen
    s_waitcnt vmcnt(3)
    s_lshl_b32 s75, s68, 5
    s_add_u32 s75, s75, s69
    s_mov_b64 exec, 1
    s_cmp_eq_u32 s92, 0
    s_cbranch_scc0 L_sf1890
    s_or_b32 s3, s71, 8
    v_mov_b32 v250, s75
    v_mov_b32 v247, s3
    buffer_store_byte v247, v250, s[60:63], 0 offen
    s_branch L_rf1890
L_sf1890:
    s_and_b32 s3, s75, 3
    s_lshl_b32 s3, s3, 3
    s_or_b32 s4, s71, 192
    s_lshl_b32 s4, s4, s3
    s_and_b32 s3, s75, 0xfc
    v_mov_b32 v250, s3
    v_mov_b32 v247, s4
    buffer_atomic_or v247, v250, s[60:63], 0 offen sc1
L_rf1890:
    s_mov_b64 exec, -1
    s_lshl_b32 s5, s68, 5
    v_and_b32 v249, 7, v1
    v_cmp_gt_u32 vcc, 4, v249
    v_lshlrev_b32 v249, 2, v249
    v_add_u32 v249, s5, v249
    v_mov_b32 v242, 0xf0f0f0f
    v_mov_b32 v241, 0xf0f0f0f
    v_cndmask_b32 v242, v242, v241, vcc
    s_mul_i32 s85, s71, 16843009
    v_and_b32 v241, 0xf8f8f8f8, v242
    v_or_b32 v241, s85, v241
    s_mov_b32 s87, 0
    s_mov_b32 s6, 0
    s_cmp_eq_u32 s92, 0
    s_cbranch_scc0 L_ps1911
L_pl1911:
    buffer_load_dword v247, v249, s[60:63], 0 offen sc1
    s_add_u32 s87, s87, 1
    s_waitcnt vmcnt(0)
    v_and_b32 v247, v242, v247
    v_cmp_ne_u32 vcc, v241, v247
    s_nop 1
    s_cmp_eq_u64 vcc, 0
    s_cbranch_scc1 L_pw1911
    s_cmp_lt_u32 s87, 64
    s_cbranch_scc1 L_pl1911
    s_lshl_b32 s75, s68, 5
    s_add_u32 s75, s75, s69
    s_mov_b64 exec, 1
    s_and_b32 s3, s75, 3
    s_lshl_b32 s3, s3, 3
    s_or_b32 s4, s71, 64
    s_lshl_b32 s4, s4, s3
    s_and_b32 s3, s75, 0xfc
    v_mov_b32 v250, s3
    v_mov_b32 v247, s4
    buffer_atomic_or v247, v250, s[60:63], 0 offen sc1
    s_mov_b64 exec, 0xff
    v_mov_b32 v247, 0
    buffer_atomic_or v247, v249, s[60:63], 0 offen sc0 sc1
    s_waitcnt vmcnt(0)
    s_or_b32 s3, s71, 64
    s_mul_i32 s3, s3, 16843009
    v_xor_b32 v247, s3, v247
    v_lshrrev_b32 v250, 6, v247
    v_not_b32 v250, v250
    v_lshrrev_b32 v243, 1, v247
    v_or_b32 v243, v243, v247
    v_lshrrev_b32 v247, 2, v247
    v_or_b32 v243, v243, v247
    v_and_b32 v243, v243, v250
    v_and_b32 v243, 0x1010101, v243
    v_cmp_ne_u32 vcc, 0, v243
    s_mov_b64 exec, -1
    s_sleep 8
    s_cmp_eq_u64 vcc, 0
    s_cselect_b32 s6, 0, 1
    s_cbranch_scc0 L_pw1911
    s_cmp_lt_u32 s87, 400000
    s_cbranch_scc1 L_pl1911
    s_branch L_pw1911
L_ps1911:
    s_mov_b64 exec, 0xff
    v_mov_b32 v247, 0
    buffer_atomic_or v247, v249, s[60:63], 0 offen sc0 sc1
    s_add_u32 s87, s87, 1
    s_mov_b32 s3, 0x80808080
    s_waitcnt vmcnt(0)
    v_and_b32 v247, s3, v247
    v_cmp_ne_u32 vcc, s3, v247
    s_mov_b64 exec, -1
    s_nop 0
    s_cmp_eq_u64 vcc, 0
    s_cbranch_scc1 L_pw1911
    s_sleep 8
    s_cmp_lt_u32 s87, 400000
    s_cbranch_scc1 L_ps1911
L_pw1911:
    s_add_u32 s6, s6, 1
    v_mov_b32 v250, 163776
    v_mov_b32 v247, s6
    ds_write_b32 v250, v247
    s_branch L_A7
L_A6:
    s_cmp_eq_u32 s70, 6
    s_mov_b32 s3, 129792
    s_cselect_b32 s75, 66560, s3
    s_cselect_b32 s95, 16, 0
    s_mov_b32 s93, 2
    v_lshlrev_b32 v112, 2, v1
    v_add_u32 v112, s75, v112
    v_and_b32 v6, 15, v1
    v_lshrrev_b32 v7, 4, v1
    v_lshlrev_b32 v8, 8, v6
    v_add_u32 v8, s75, v8
    v_or_b32 v9, 0, v7
    v_xor_b32 v9, v9, v6
    v_lshlrev_b32 v9, 4, v9
    v_add_u32 v114, v8, v9
    v_or_b32 v9, 4, v7
    v_xor_b32 v9, v9, v6
    v_lshlrev_b32 v9, 4, v9
    v_add_u32 v115, v8, v9
    v_or_b32 v9, 8, v7
    v_xor_b32 v9, v9, v6
    v_lshlrev_b32 v9, 4, v9
    v_add_u32 v116, v8, v9
    v_or_b32 v9, 12, v7
    v_xor_b32 v9, v9, v6
    v_lshlrev_b32 v9, 4, v9
    v_add_u32 v117, v8, v9
    s_waitcnt vmcnt(0)
    s_call_b64 s[64:65], L_KS
    s_call_b64 s[64:65], L_KV
    s_waitcnt lgkmcnt(8)
    v_mfma_f32_16x16x32_bf16 v[40:43], v[150:153], v[134:137], 0
    v_mfma_f32_16x16x32_bf16 v[40:43], v[154:157], v[138:141], v[40:43]
    v_mfma_f32_16x16x32_bf16 v[40:43], v[158:161], v[142:145], v[40:43]
    v_mfma_f32_16x16x32_bf16 v[40:43], v[162:165], v[146:149], v[40:43]
    s_waitcnt lgkmcnt(4)
    v_mfma_f32_16x16x32_bf16 v[44:47], v[166:169], v[134:137], 0
    v_mfma_f32_16x16x32_bf16 v[44:47], v[170:173], v[138:141], v[44:47]
    v_mfma_f32_16x16x32_bf16 v[44:47], v[174:177], v[142:145], v[44:47]
    v_mfma_f32_16x16x32_bf16 v[44:47], v[178:181], v[146:149], v[44:47]
    s_waitcnt lgkmcnt(0)
    v_mfma_f32_16x16x32_bf16 v[48:51], v[182:185], v[134:137], 0
    v_mfma_f32_16x16x32_bf16 v[48:51], v[186:189], v[138:141], v[48:51]
    v_mfma_f32_16x16x32_bf16 v[48:51], v[190:193], v[142:145], v[48:51]
    v_mfma_f32_16x16x32_bf16 v[48:51], v[194:197], v[146:149], v[48:51]
    s_nop 7
    s_sub_u32 s3, s70, 6
    s_mul_i32 s3, s3, 3072
    s_add_u32 s3, s3, 146176
    v_lshlrev_b32 v6, 4, v1
    v_add_u32 v6, s3, v6
    ds_write_b128 v6, v[40:43] offset:0
    ds_write_b128 v6, v[44:47] offset:1024
    ds_write_b128 v6, v[48:51] offset:2048
    s_waitcnt lgkmcnt(0)
    v_mov_b32 v250, 163780
    v_mov_b32 v247, 1
    s_mov_b64 exec, 1
    ds_add_u32 v250, v247
    s_mov_b64 exec, -1
    v_mov_b32 v250, 163776
    s_mov_b32 s4, 0
L_go2053:
    ds_read_b32 v247, v250
    s_add_u32 s4, s4, 1
    s_waitcnt lgkmcnt(0)
    v_readfirstlane_b32 s3, v247
    s_cmp_ge_u32 s4, 0x1000000
    s_cbranch_scc1 L_gx2053
    s_cmp_lt_u32 s3, 1
    s_cbranch_scc0 L_gx2053
    s_sleep 1
    s_branch L_go2053
L_gx2053:
L_A7:
    s_setprio 1
    s_sub_u32 s93, s70, 5
    s_lshl_b32 s93, s93, 1
L_uo2071:
    s_mul_i32 s94, s69, 5
    s_add_u32 s94, s94, s93
    s_lshl_b32 s94, s94, 12
    s_mul_i32 s86, s93, 9280
    s_add_u32 s86, s86, 83200
    v_lshlrev_b32 v6, 4, v1
    buffer_load_dwordx4 v[72:75], v6, s[52:55], s94 offen offset:0 sc1
    buffer_load_dwordx4 v[76:79], v6, s[52:55], s94 offen offset:1024 sc1
    buffer_load_dwordx4 v[80:83], v6, s[52:55], s94 offen offset:2048 sc1
    buffer_load_dwordx4 v[84:87], v6, s[52:55], s94 offen offset:3072 sc1
    v_lshlrev_b32 v7, 3, v1
    v_add_u32 v7, s86, v7
    v_mov_b32 v244, 0
    v_mov_b32 v245, 0
    s_mov_b32 exec_hi, 0x03ffffff
    ds_write_b64 v7, v[244:245] offset:4104
    ds_write_b64 v7, v[244:245] offset:8752
    s_mov_b64 exec, -1
    v_lshlrev_b32 v6, 4, v1
    v_add_u32 v6, s86, v6
    s_waitcnt vmcnt(3)
    ds_write_b128 v6, v[72:75] offset:4656
    ds_write_b64 v6, v[72:73] offset:8
    ds_write_b64 v6, v[74:75] offset:16
    s_waitcnt vmcnt(2)
    ds_write_b128 v6, v[76:79] offset:5680
    ds_write_b64 v6, v[76:77] offset:1032
    ds_write_b64 v6, v[78:79] offset:1040
    s_waitcnt vmcnt(1)
    ds_write_b128 v6, v[80:83] offset:6704
    ds_write_b64 v6, v[80:81] offset:2056
    ds_write_b64 v6, v[82:83] offset:2064
    s_waitcnt vmcnt(0)
    ds_write_b128 v6, v[84:87] offset:7728
    ds_write_b64 v6, v[84:85] offset:3080
    ds_write_b64 v6, v[86:87] offset:3088
    s_add_u32 s93, s93, 1
    s_cmp_eq_u32 s93, 5
    s_cbranch_scc1 L_uq2071
    s_bitcmp1_b32 s93, 0
    s_cbranch_scc1 L_uo2071
    s_waitcnt lgkmcnt(0)
    v_mov_b32 v250, 163804
    v_mov_b32 v247, 1
    s_mov_b64 exec, 1
    ds_add_u32 v250, v247
    s_mov_b64 exec, -1
    s_branch L_ur2071
L_uq2071:
    s_waitcnt lgkmcnt(0)
    v_mov_b32 v250, 163796
    v_mov_b32 v247, 1
    s_mov_b64 exec, 1
    ds_add_u32 v250, v247
    s_mov_b64 exec, -1
L_ur2071:
    s_setprio 0
    s_branch L_CV
L_KS:
    v_lshlrev_b32 v54, 16, v30
    v_lshlrev_b32 v52, s95, v26
    v_lshlrev_b32 v53, s95, v27
    v_mul_f32 v54, 0x3fb8aa3b, v54
    v_and_b32 v52, s76, v52
    v_and_b32 v53, s76, v53
    v_exp_f32 v54, v54
    v_mul_f32 v52, 0x3fb8aa3b, v52
    v_lshlrev_b32 v56, s95, v28
    v_cvt_pk_bf16_f32 v54, v54, v54
    v_exp_f32 v52, v52
    v_and_b32 v56, s76, v56
    v_and_b32 v54, s76, v54
    v_cvt_pk_bf16_f32 v52, v52, v52
    v_lshlrev_b32 v57, s95, v29
    v_add_f32 v55, v54, v54
    v_and_b32 v52, s76, v52
    v_and_b32 v57, s76, v57
    v_mul_f32 v52, v52, v54
    v_mul_f32 v53, v53, v54
    v_mul_f32 v56, v56, v55
    v_mul_f32 v52, 0xbfb8aa3b, v52
    v_mul_f32 v53, 0x3e22f983, v53
    v_mul_f32 v57, v57, v55
    v_mul_f32 v58, 0x41000000, v52
    v_mul_f32 v60, 0x43000000, v52
    v_exp_f32 v62, v52
    v_mul_f32 v59, 0x41000000, v53
    v_mul_f32 v61, 0x43000000, v53
    v_fract_f32 v63, v53
    v_exp_f32 v58, v58
    v_exp_f32 v60, v60
    v_cos_f32 v64, v63
    v_fract_f32 v59, v59
    v_fract_f32 v61, v61
    v_sin_f32 v65, v63
    v_cos_f32 v70, v59
    v_cos_f32 v72, v61
    v_mul_f32 v64, v62, v64
    v_sin_f32 v71, v59
    v_sin_f32 v73, v61
    v_mul_f32 v65, v62, v65
    v_mul_f32 v70, v58, v70
    v_mul_f32 v72, v60, v72
    v_mul_f32 v71, v58, v71
    v_mul_f32 v73, v60, v73
    v_pk_mul_f32 v[66:67], v[64:65], v[64:65] op_sel_hi:[0,1]
    v_pk_mul_f32 v[74:75], v[72:73], v[72:73] op_sel_hi:[0,1]
    v_pk_fma_f32 v[66:67], v[64:65], v[64:65], v[66:67] op_sel:[1,1,0] op_sel_hi:[1,0,1] neg_lo:[1,0,0]
    v_pk_fma_f32 v[74:75], v[72:73], v[72:73], v[74:75] op_sel:[1,1,0] op_sel_hi:[1,0,1] neg_lo:[1,0,0]
    v_pk_mul_f32 v[68:69], v[66:67], v[66:67] op_sel_hi:[0,1]
    v_pk_mul_f32 v[76:77], v[74:75], v[74:75] op_sel_hi:[0,1]
    v_pk_fma_f32 v[68:69], v[66:67], v[66:67], v[68:69] op_sel:[1,1,0] op_sel_hi:[1,0,1] neg_lo:[1,0,0]
    v_pk_fma_f32 v[76:77], v[74:75], v[74:75], v[76:77] op_sel:[1,1,0] op_sel_hi:[1,0,1] neg_lo:[1,0,0]
    v_pk_mul_f32 v[78:79], v[76:77], v[76:77] op_sel_hi:[0,1]
    v_pk_fma_f32 v[78:79], v[76:77], v[76:77], v[78:79] op_sel:[1,1,0] op_sel_hi:[1,0,1] neg_lo:[1,0,0]
    v_pk_mul_f32 v[80:81], v[78:79], v[78:79] op_sel_hi:[0,1]
    v_pk_fma_f32 v[80:81], v[78:79], v[78:79], v[80:81] op_sel:[1,1,0] op_sel_hi:[1,0,1] neg_lo:[1,0,0]
    v_pk_mul_f32 v[90:91], v[56:57], v[74:75] op_sel_hi:[0,1]
    v_pk_mul_f32 v[98:99], v[56:57], v[78:79] op_sel_hi:[0,1]
    v_pk_fma_f32 v[90:91], v[56:57], v[74:75], v[90:91] op_sel:[1,1,0] op_sel_hi:[1,0,1] neg_lo:[1,0,0]
    v_pk_fma_f32 v[98:99], v[56:57], v[78:79], v[98:99] op_sel:[1,1,0] op_sel_hi:[1,0,1] neg_lo:[1,0,0]
    v_mov_b32 v82, 1.0
    v_mov_b32 v83, 0
    s_setpc_b64 s[64:65]
L_KV:
    v_xor_b32 v110, 0, v112
    v_cvt_pk_bf16_f32 v102, v82, -v83
    v_cvt_pk_bf16_f32 v103, v56, v57
    v_cvt_pk_bf16_f32 v104, v90, v91
    v_cvt_pk_bf16_f32 v105, v98, v99
    ds_write2st64_b32 v110, v102, v103 offset0:0 offset1:16
    ds_write2st64_b32 v110, v104, v105 offset0:32 offset1:48
    v_mov_b32 v84, v70
    v_pk_mul_f32 v[86:87], v[56:57], v[64:65] op_sel_hi:[0,1]
    v_pk_mul_f32 v[92:93], v[90:91], v[66:67] op_sel_hi:[0,1]
    v_pk_mul_f32 v[100:101], v[98:99], v[72:73] op_sel_hi:[0,1]
    v_xor_b32 v111, 16, v112
    v_mov_b32 v85, v71
    v_pk_fma_f32 v[86:87], v[56:57], v[64:65], v[86:87] op_sel:[1,1,0] op_sel_hi:[1,0,1] neg_lo:[1,0,0]
    v_pk_fma_f32 v[92:93], v[90:91], v[66:67], v[92:93] op_sel:[1,1,0] op_sel_hi:[1,0,1] neg_lo:[1,0,0]
    v_pk_fma_f32 v[100:101], v[98:99], v[72:73], v[100:101] op_sel:[1,1,0] op_sel_hi:[1,0,1] neg_lo:[1,0,0]
    v_cvt_pk_bf16_f32 v106, v84, -v85
    v_cvt_pk_bf16_f32 v107, v86, v87
    v_cvt_pk_bf16_f32 v108, v92, v93
    v_cvt_pk_bf16_f32 v109, v100, v101
    ds_write2st64_b32 v111, v106, v107 offset0:1 offset1:17
    ds_write2st64_b32 v111, v108, v109 offset0:33 offset1:49
    v_pk_mul_f32 v[82:83], v[84:85], v[70:71] op_sel_hi:[0,1]
    v_pk_mul_f32 v[88:89], v[86:87], v[64:65] op_sel_hi:[0,1]
    v_pk_mul_f32 v[94:95], v[92:93], v[66:67] op_sel_hi:[0,1]
    v_pk_mul_f32 v[98:99], v[100:101], v[72:73] op_sel_hi:[0,1]
    v_xor_b32 v110, 32, v112
    v_pk_fma_f32 v[82:83], v[84:85], v[70:71], v[82:83] op_sel:[1,1,0] op_sel_hi:[1,0,1] neg_lo:[1,0,0]
    v_pk_fma_f32 v[88:89], v[86:87], v[64:65], v[88:89] op_sel:[1,1,0] op_sel_hi:[1,0,1] neg_lo:[1,0,0]
    v_pk_fma_f32 v[94:95], v[92:93], v[66:67], v[94:95] op_sel:[1,1,0] op_sel_hi:[1,0,1] neg_lo:[1,0,0]
    v_pk_fma_f32 v[98:99], v[100:101], v[72:73], v[98:99] op_sel:[1,1,0] op_sel_hi:[1,0,1] neg_lo:[1,0,0]
    v_cvt_pk_bf16_f32 v102, v82, -v83
    v_cvt_pk_bf16_f32 v103, v88, v89
    v_cvt_pk_bf16_f32 v104, v94, v95
    v_cvt_pk_bf16_f32 v105, v98, v99
    ds_write2st64_b32 v110, v102, v103 offset0:2 offset1:18
    ds_write2st64_b32 v110, v104, v105 offset0:34 offset1:50
    v_pk_mul_f32 v[84:85], v[82:83], v[70:71] op_sel_hi:[0,1]
    v_pk_mul_f32 v[86:87], v[88:89], v[64:65] op_sel_hi:[0,1]
    v_pk_mul_f32 v[92:93], v[94:95], v[66:67] op_sel_hi:[0,1]
    v_pk_mul_f32 v[100:101], v[98:99], v[72:73] op_sel_hi:[0,1]
    v_xor_b32 v111, 48, v112
    v_pk_fma_f32 v[84:85], v[82:83], v[70:71], v[84:85] op_sel:[1,1,0] op_sel_hi:[1,0,1] neg_lo:[1,0,0]
    v_pk_fma_f32 v[86:87], v[88:89], v[64:65], v[86:87] op_sel:[1,1,0] op_sel_hi:[1,0,1] neg_lo:[1,0,0]
    v_pk_fma_f32 v[92:93], v[94:95], v[66:67], v[92:93] op_sel:[1,1,0] op_sel_hi:[1,0,1] neg_lo:[1,0,0]
    v_pk_fma_f32 v[100:101], v[98:99], v[72:73], v[100:101] op_sel:[1,1,0] op_sel_hi:[1,0,1] neg_lo:[1,0,0]
    v_cvt_pk_bf16_f32 v106, v84, -v85
    v_cvt_pk_bf16_f32 v107, v86, v87
    v_cvt_pk_bf16_f32 v108, v92, v93
    v_cvt_pk_bf16_f32 v109, v100, v101
    ds_write2st64_b32 v111, v106, v107 offset0:3 offset1:19
    ds_write2st64_b32 v111, v108, v109 offset0:35 offset1:51
    v_pk_mul_f32 v[82:83], v[84:85], v[70:71] op_sel_hi:[0,1]
    v_pk_mul_f32 v[88:89], v[86:87], v[64:65] op_sel_hi:[0,1]
    v_pk_mul_f32 v[96:97], v[90:91], v[72:73] op_sel_hi:[0,1]
    v_pk_mul_f32 v[98:99], v[100:101], v[72:73] op_sel_hi:[0,1]
    v_xor_b32 v110, 64, v112
    v_pk_fma_f32 v[82:83], v[84:85], v[70:71], v[82:83] op_sel:[1,1,0] op_sel_hi:[1,0,1] neg_lo:[1,0,0]
    v_pk_fma_f32 v[88:89], v[86:87], v[64:65], v[88:89] op_sel:[1,1,0] op_sel_hi:[1,0,1] neg_lo:[1,0,0]
    v_pk_fma_f32 v[96:97], v[90:91], v[72:73], v[96:97] op_sel:[1,1,0] op_sel_hi:[1,0,1] neg_lo:[1,0,0]
    v_pk_fma_f32 v[98:99], v[100:101], v[72:73], v[98:99] op_sel:[1,1,0] op_sel_hi:[1,0,1] neg_lo:[1,0,0]
    v_cvt_pk_bf16_f32 v102, v82, -v83
    v_cvt_pk_bf16_f32 v103, v88, v89
    v_cvt_pk_bf16_f32 v104, v96, v97
    v_cvt_pk_bf16_f32 v105, v98, v99
    ds_write2st64_b32 v110, v102, v103 offset0:4 offset1:20
    ds_write2st64_b32 v110, v104, v105 offset0:36 offset1:52
    v_pk_mul_f32 v[84:85], v[82:83], v[70:71] op_sel_hi:[0,1]
    v_pk_mul_f32 v[86:87], v[88:89], v[64:65] op_sel_hi:[0,1]
    v_pk_mul_f32 v[92:93], v[96:97], v[66:67] op_sel_hi:[0,1]
    v_pk_mul_f32 v[100:101], v[98:99], v[72:73] op_sel_hi:[0,1]
    v_xor_b32 v111, 80, v112
    v_pk_fma_f32 v[84:85], v[82:83], v[70:71], v[84:85] op_sel:[1,1,0] op_sel_hi:[1,0,1] neg_lo:[1,0,0]
    v_pk_fma_f32 v[86:87], v[88:89], v[64:65], v[86:87] op_sel:[1,1,0] op_sel_hi:[1,0,1] neg_lo:[1,0,0]
    v_pk_fma_f32 v[92:93], v[96:97], v[66:67], v[92:93] op_sel:[1,1,0] op_sel_hi:[1,0,1] neg_lo:[1,0,0]
    v_pk_fma_f32 v[100:101], v[98:99], v[72:73], v[100:101] op_sel:[1,1,0] op_sel_hi:[1,0,1] neg_lo:[1,0,0]
    v_cvt_pk_bf16_f32 v106, v84, -v85
    v_cvt_pk_bf16_f32 v107, v86, v87
    v_cvt_pk_bf16_f32 v108, v92, v93
    v_cvt_pk_bf16_f32 v109, v100, v101
    ds_write2st64_b32 v111, v106, v107 offset0:5 offset1:21
    ds_write2st64_b32 v111, v108, v109 offset0:37 offset1:53
    v_pk_mul_f32 v[82:83], v[84:85], v[70:71] op_sel_hi:[0,1]
    v_pk_mul_f32 v[88:89], v[86:87], v[64:65] op_sel_hi:[0,1]
    v_pk_mul_f32 v[94:95], v[92:93], v[66:67] op_sel_hi:[0,1]
    v_pk_mul_f32 v[98:99], v[100:101], v[72:73] op_sel_hi:[0,1]
    v_xor_b32 v110, 96, v112
    v_pk_fma_f32 v[82:83], v[84:85], v[70:71], v[82:83] op_sel:[1,1,0] op_sel_hi:[1,0,1] neg_lo:[1,0,0]
    v_pk_fma_f32 v[88:89], v[86:87], v[64:65], v[88:89] op_sel:[1,1,0] op_sel_hi:[1,0,1] neg_lo:[1,0,0]
    v_pk_fma_f32 v[94:95], v[92:93], v[66:67], v[94:95] op_sel:[1,1,0] op_sel_hi:[1,0,1] neg_lo:[1,0,0]
    v_pk_fma_f32 v[98:99], v[100:101], v[72:73], v[98:99] op_sel:[1,1,0] op_sel_hi:[1,0,1] neg_lo:[1,0,0]
    v_cvt_pk_bf16_f32 v102, v82, -v83
    v_cvt_pk_bf16_f32 v103, v88, v89
    v_cvt_pk_bf16_f32 v104, v94, v95
    v_cvt_pk_bf16_f32 v105, v98, v99
    ds_write2st64_b32 v110, v102, v103 offset0:6 offset1:22
    ds_write2st64_b32 v110, v104, v105 offset0:38 offset1:54
    v_pk_mul_f32 v[84:85], v[82:83], v[70:71] op_sel_hi:[0,1]
    v_pk_mul_f32 v[86:87], v[88:89], v[64:65] op_sel_hi:[0,1]
    v_pk_mul_f32 v[92:93], v[94:95], v[66:67] op_sel_hi:[0,1]
    v_pk_mul_f32 v[100:101], v[98:99], v[72:73] op_sel_hi:[0,1]
    v_xor_b32 v111, 112, v112
    v_pk_fma_f32 v[84:85], v[82:83], v[70:71], v[84:85] op_sel:[1,1,0] op_sel_hi:[1,0,1] neg_lo:[1,0,0]
    v_pk_fma_f32 v[86:87], v[88:89], v[64:65], v[86:87] op_sel:[1,1,0] op_sel_hi:[1,0,1] neg_lo:[1,0,0]
    v_pk_fma_f32 v[92:93], v[94:95], v[66:67], v[92:93] op_sel:[1,1,0] op_sel_hi:[1,0,1] neg_lo:[1,0,0]
    v_pk_fma_f32 v[100:101], v[98:99], v[72:73], v[100:101] op_sel:[1,1,0] op_sel_hi:[1,0,1] neg_lo:[1,0,0]
    v_cvt_pk_bf16_f32 v106, v84, -v85
    v_cvt_pk_bf16_f32 v107, v86, v87
    v_cvt_pk_bf16_f32 v108, v92, v93
    v_cvt_pk_bf16_f32 v109, v100, v101
    ds_write2st64_b32 v111, v106, v107 offset0:7 offset1:23
    ds_write2st64_b32 v111, v108, v109 offset0:39 offset1:55
    v_pk_mul_f32 v[82:83], v[84:85], v[70:71] op_sel_hi:[0,1]
    v_pk_mul_f32 v[86:87], v[56:57], v[72:73] op_sel_hi:[0,1]
    v_pk_mul_f32 v[90:91], v[56:57], v[76:77] op_sel_hi:[0,1]
    v_pk_mul_f32 v[98:99], v[56:57], v[80:81] op_sel_hi:[0,1]
    v_xor_b32 v110, 128, v112
    v_pk_fma_f32 v[82:83], v[84:85], v[70:71], v[82:83] op_sel:[1,1,0] op_sel_hi:[1,0,1] neg_lo:[1,0,0]
    v_pk_fma_f32 v[86:87], v[56:57], v[72:73], v[86:87] op_sel:[1,1,0] op_sel_hi:[1,0,1] neg_lo:[1,0,0]
    v_pk_fma_f32 v[90:91], v[56:57], v[76:77], v[90:91] op_sel:[1,1,0] op_sel_hi:[1,0,1] neg_lo:[1,0,0]
    v_pk_fma_f32 v[98:99], v[56:57], v[80:81], v[98:99] op_sel:[1,1,0] op_sel_hi:[1,0,1] neg_lo:[1,0,0]
    v_cvt_pk_bf16_f32 v102, v82, -v83
    v_cvt_pk_bf16_f32 v103, v86, v87
    v_cvt_pk_bf16_f32 v104, v90, v91
    v_cvt_pk_bf16_f32 v105, v98, v99
    ds_write2st64_b32 v110, v102, v103 offset0:8 offset1:24
    ds_write2st64_b32 v110, v104, v105 offset0:40 offset1:56
    v_pk_mul_f32 v[84:85], v[82:83], v[70:71] op_sel_hi:[0,1]
    v_pk_mul_f32 v[88:89], v[86:87], v[64:65] op_sel_hi:[0,1]
    v_pk_mul_f32 v[92:93], v[90:91], v[68:69] op_sel_hi:[0,1]
    v_xor_b32 v111, 144, v112
    v_pk_fma_f32 v[84:85], v[82:83], v[70:71], v[84:85] op_sel:[1,1,0] op_sel_hi:[1,0,1] neg_lo:[1,0,0]
    v_pk_fma_f32 v[88:89], v[86:87], v[64:65], v[88:89] op_sel:[1,1,0] op_sel_hi:[1,0,1] neg_lo:[1,0,0]
    v_pk_fma_f32 v[92:93], v[90:91], v[68:69], v[92:93] op_sel:[1,1,0] op_sel_hi:[1,0,1] neg_lo:[1,0,0]
    v_cvt_pk_bf16_f32 v106, v84, -v85
    v_cvt_pk_bf16_f32 v107, v88, v89
    v_cvt_pk_bf16_f32 v108, v92, v93
    ds_write2st64_b32 v111, v106, v107 offset0:9 offset1:25
    ds_write_b32 v111, v108 offset:10496
    v_pk_mul_f32 v[82:83], v[84:85], v[70:71] op_sel_hi:[0,1]
    v_pk_mul_f32 v[86:87], v[88:89], v[64:65] op_sel_hi:[0,1]
    v_pk_mul_f32 v[94:95], v[90:91], v[72:73] op_sel_hi:[0,1]
    v_xor_b32 v110, 160, v112
    v_pk_fma_f32 v[82:83], v[84:85], v[70:71], v[82:83] op_sel:[1,1,0] op_sel_hi:[1,0,1] neg_lo:[1,0,0]
    v_pk_fma_f32 v[86:87], v[88:89], v[64:65], v[86:87] op_sel:[1,1,0] op_sel_hi:[1,0,1] neg_lo:[1,0,0]
    v_pk_fma_f32 v[94:95], v[90:91], v[72:73], v[94:95] op_sel:[1,1,0] op_sel_hi:[1,0,1] neg_lo:[1,0,0]
    v_cvt_pk_bf16_f32 v102, v82, -v83
    v_cvt_pk_bf16_f32 v103, v86, v87
    v_cvt_pk_bf16_f32 v104, v94, v95
    ds_write2st64_b32 v110, v102, v103 offset0:10 offset1:26
    ds_write_b32 v110, v104 offset:10752
    v_pk_mul_f32 v[84:85], v[82:83], v[70:71] op_sel_hi:[0,1]
    v_pk_mul_f32 v[88:89], v[86:87], v[64:65] op_sel_hi:[0,1]
    v_pk_mul_f32 v[96:97], v[92:93], v[72:73] op_sel_hi:[0,1]
    v_xor_b32 v111, 176, v112
    v_pk_fma_f32 v[84:85], v[82:83], v[70:71], v[84:85] op_sel:[1,1,0] op_sel_hi:[1,0,1] neg_lo:[1,0,0]
    v_pk_fma_f32 v[88:89], v[86:87], v[64:65], v[88:89] op_sel:[1,1,0] op_sel_hi:[1,0,1] neg_lo:[1,0,0]
    v_pk_fma_f32 v[96:97], v[92:93], v[72:73], v[96:97] op_sel:[1,1,0] op_sel_hi:[1,0,1] neg_lo:[1,0,0]
    v_cvt_pk_bf16_f32 v106, v84, -v85
    v_cvt_pk_bf16_f32 v107, v88, v89
    v_cvt_pk_bf16_f32 v108, v96, v97
    ds_write2st64_b32 v111, v106, v107 offset0:11 offset1:27
    ds_write_b32 v111, v108 offset:11008
    v_pk_mul_f32 v[82:83], v[84:85], v[70:71] op_sel_hi:[0,1]
    v_pk_mul_f32 v[86:87], v[88:89], v[64:65] op_sel_hi:[0,1]
    v_pk_mul_f32 v[90:91], v[94:95], v[72:73] op_sel_hi:[0,1]
    v_xor_b32 v110, 192, v112
    v_pk_fma_f32 v[82:83], v[84:85], v[70:71], v[82:83] op_sel:[1,1,0] op_sel_hi:[1,0,1] neg_lo:[1,0,0]
    v_pk_fma_f32 v[86:87], v[88:89], v[64:65], v[86:87] op_sel:[1,1,0] op_sel_hi:[1,0,1] neg_lo:[1,0,0]
    v_pk_fma_f32 v[90:91], v[94:95], v[72:73], v[90:91] op_sel:[1,1,0] op_sel_hi:[1,0,1] neg_lo:[1,0,0]
    v_cvt_pk_bf16_f32 v102, v82, -v83
    v_cvt_pk_bf16_f32 v103, v86, v87
    v_cvt_pk_bf16_f32 v104, v90, v91
    ds_write2st64_b32 v110, v102, v103 offset0:12 offset1:28
    ds_write_b32 v110, v104 offset:11264
    v_pk_mul_f32 v[84:85], v[82:83], v[70:71] op_sel_hi:[0,1]
    v_pk_mul_f32 v[88:89], v[86:87], v[64:65] op_sel_hi:[0,1]
    v_pk_mul_f32 v[92:93], v[96:97], v[72:73] op_sel_hi:[0,1]
    v_xor_b32 v111, 208, v112
    v_pk_fma_f32 v[84:85], v[82:83], v[70:71], v[84:85] op_sel:[1,1,0] op_sel_hi:[1,0,1] neg_lo:[1,0,0]
    v_pk_fma_f32 v[88:89], v[86:87], v[64:65], v[88:89] op_sel:[1,1,0] op_sel_hi:[1,0,1] neg_lo:[1,0,0]
    v_pk_fma_f32 v[92:93], v[96:97], v[72:73], v[92:93] op_sel:[1,1,0] op_sel_hi:[1,0,1] neg_lo:[1,0,0]
    v_cvt_pk_bf16_f32 v106, v84, -v85
    v_cvt_pk_bf16_f32 v107, v88, v89
    v_cvt_pk_bf16_f32 v108, v92, v93
    ds_write2st64_b32 v111, v106, v107 offset0:13 offset1:29
    ds_write_b32 v111, v108 offset:11520
    v_pk_mul_f32 v[82:83], v[84:85], v[70:71] op_sel_hi:[0,1]
    v_pk_mul_f32 v[86:87], v[88:89], v[64:65] op_sel_hi:[0,1]
    v_pk_mul_f32 v[94:95], v[90:91], v[72:73] op_sel_hi:[0,1]
    v_xor_b32 v110, 224, v112
    v_pk_fma_f32 v[82:83], v[84:85], v[70:71], v[82:83] op_sel:[1,1,0] op_sel_hi:[1,0,1] neg_lo:[1,0,0]
    v_pk_fma_f32 v[86:87], v[88:89], v[64:65], v[86:87] op_sel:[1,1,0] op_sel_hi:[1,0,1] neg_lo:[1,0,0]
    v_pk_fma_f32 v[94:95], v[90:91], v[72:73], v[94:95] op_sel:[1,1,0] op_sel_hi:[1,0,1] neg_lo:[1,0,0]
    v_cvt_pk_bf16_f32 v102, v82, -v83
    v_cvt_pk_bf16_f32 v103, v86, v87
    v_cvt_pk_bf16_f32 v104, v94, v95
    ds_write2st64_b32 v110, v102, v103 offset0:14 offset1:30
    ds_write_b32 v110, v104 offset:11776
    v_pk_mul_f32 v[84:85], v[82:83], v[70:71] op_sel_hi:[0,1]
    v_pk_mul_f32 v[88:89], v[86:87], v[64:65] op_sel_hi:[0,1]
    v_pk_mul_f32 v[96:97], v[92:93], v[72:73] op_sel_hi:[0,1]
    v_xor_b32 v111, 240, v112
    v_pk_fma_f32 v[84:85], v[82:83], v[70:71], v[84:85] op_sel:[1,1,0] op_sel_hi:[1,0,1] neg_lo:[1,0,0]
    v_pk_fma_f32 v[88:89], v[86:87], v[64:65], v[88:89] op_sel:[1,1,0] op_sel_hi:[1,0,1] neg_lo:[1,0,0]
    v_pk_fma_f32 v[96:97], v[92:93], v[72:73], v[96:97] op_sel:[1,1,0] op_sel_hi:[1,0,1] neg_lo:[1,0,0]
    v_cvt_pk_bf16_f32 v106, v84, -v85
    v_cvt_pk_bf16_f32 v107, v88, v89
    v_cvt_pk_bf16_f32 v108, v96, v97
    ds_write2st64_b32 v111, v106, v107 offset0:15 offset1:31
    ds_write_b32 v111, v108 offset:12032
    s_waitcnt lgkmcnt(0)
    ds_read_b128 v[134:137], v114
    ds_read_b128 v[138:141], v115
    ds_read_b128 v[142:145], v116
    ds_read_b128 v[146:149], v117
    ds_read_b128 v[150:153], v114 offset:4096
    ds_read_b128 v[154:157], v115 offset:4096
    ds_read_b128 v[158:161], v116 offset:4096
    ds_read_b128 v[162:165], v117 offset:4096
    ds_read_b128 v[166:169], v114 offset:8192
    ds_read_b128 v[170:173], v115 offset:8192
    ds_read_b128 v[174:177], v116 offset:8192
    ds_read_b128 v[178:181], v117 offset:8192
    ds_read_b128 v[182:185], v114 offset:12288
    ds_read_b128 v[186:189], v115 offset:12288
    ds_read_b128 v[190:193], v116 offset:12288
    ds_read_b128 v[194:197], v117 offset:12288
    s_setpc_b64 s[64:65]
L_CV:
    v_mov_b32 v250, 163776
    s_mov_b32 s4, 0
L_go2427:
    ds_read_b32 v247, v250
    s_add_u32 s4, s4, 1
    s_waitcnt lgkmcnt(0)
    v_readfirstlane_b32 s3, v247
    s_cmp_ge_u32 s4, 0x1000000
    s_cbranch_scc1 L_gx2427
    s_cmp_lt_u32 s3, 1
    s_cbranch_scc0 L_gx2427
    s_sleep 1
    s_branch L_go2427
L_gx2427:
L_CVK:
    s_cmp_eq_u32 s3, 2
    s_cbranch_scc0 L_CV1
    s_waitcnt vmcnt(0) lgkmcnt(0)
    s_barrier
    s_mov_b32 s92, 1
    s_branch L_START
L_CV1:
    s_waitcnt lgkmcnt(0)
    s_cmp_eq_u32 s70, 4
    s_cbranch_scc1 L_W4
    s_cmp_ge_u32 s70, 5
    s_cbranch_scc1 L_W5
    ds_read_b128 v[72:75], v200 offset:0
    ds_read_b128 v[104:107], v201 offset:3584
    ds_read_b128 v[76:79], v200 offset:512
    ds_read_b128 v[108:111], v201 offset:3072
    ds_read_b128 v[80:83], v200 offset:1024
    ds_read_b128 v[112:115], v201 offset:2560
    ds_read_b128 v[84:87], v200 offset:1536
    ds_read_b128 v[116:119], v201 offset:2048
    ds_read_b128 v[88:91], v200 offset:2048
    ds_read_b128 v[120:123], v201 offset:1536
    ds_read_b128 v[92:95], v200 offset:2560
    ds_read_b128 v[124:127], v201 offset:1024
    ds_read_b128 v[96:99], v200 offset:3072
    ds_read_b128 v[128:131], v201 offset:512
    ds_read_b128 v[100:103], v200 offset:3584
    ds_read_b128 v[132:135], v201 offset:0
    s_waitcnt lgkmcnt(14)
    v_mfma_f32_16x16x32_bf16 v[8:11], v[72:75], v[104:107], 0
    s_waitcnt lgkmcnt(12)
    v_mfma_f32_16x16x32_bf16 v[12:15], v[72:75], v[108:111], 0
    v_mfma_f32_16x16x32_bf16 v[12:15], v[76:79], v[104:107], v[12:15]
    v_mfma_f32_16x16x32_bf16 v[16:19], v[76:79], v[108:111], 0
    s_waitcnt lgkmcnt(10)
    v_mfma_f32_16x16x32_bf16 v[16:19], v[72:75], v[112:115], v[16:19]
    v_mfma_f32_16x16x32_bf16 v[20:23], v[76:79], v[112:115], 0
    v_mfma_f32_16x16x32_bf16 v[16:19], v[80:83], v[104:107], v[16:19]
    v_mfma_f32_16x16x32_bf16 v[20:23], v[80:83], v[108:111], v[20:23]
    v_mfma_f32_16x16x32_bf16 v[24:27], v[80:83], v[112:115], 0
    s_waitcnt lgkmcnt(8)
    v_mfma_f32_16x16x32_bf16 v[20:23], v[72:75], v[116:119], v[20:23]
    v_mfma_f32_16x16x32_bf16 v[24:27], v[76:79], v[116:119], v[24:27]
    v_mfma_f32_16x16x32_bf16 v[28:31], v[80:83], v[116:119], 0
    v_mfma_f32_16x16x32_bf16 v[20:23], v[84:87], v[104:107], v[20:23]
    v_mfma_f32_16x16x32_bf16 v[24:27], v[84:87], v[108:111], v[24:27]
    v_mfma_f32_16x16x32_bf16 v[28:31], v[84:87], v[112:115], v[28:31]
    v_mfma_f32_16x16x32_bf16 v[32:35], v[84:87], v[116:119], 0
    s_waitcnt lgkmcnt(0)
    v_mfma_f32_16x16x32_bf16 v[24:27], v[72:75], v[120:123], v[24:27]
    ds_read_b128 v[136:139], v200 offset:64
    v_mfma_f32_16x16x32_bf16 v[28:31], v[76:79], v[120:123], v[28:31]
    ds_read_b128 v[168:171], v201 offset:3648
    v_mfma_f32_16x16x32_bf16 v[32:35], v[80:83], v[120:123], v[32:35]
    ds_read_b128 v[140:143], v200 offset:576
    v_mfma_f32_16x16x32_bf16 v[36:39], v[84:87], v[120:123], 0
    ds_read_b128 v[172:175], v201 offset:3136
    v_mfma_f32_16x16x32_bf16 v[24:27], v[88:91], v[104:107], v[24:27]
    ds_read_b128 v[144:147], v200 offset:1088
    v_mfma_f32_16x16x32_bf16 v[28:31], v[88:91], v[108:111], v[28:31]
    ds_read_b128 v[176:179], v201 offset:2624
    v_mfma_f32_16x16x32_bf16 v[32:35], v[88:91], v[112:115], v[32:35]
    ds_read_b128 v[148:151], v200 offset:1600
    v_mfma_f32_16x16x32_bf16 v[36:39], v[88:91], v[116:119], v[36:39]
    ds_read_b128 v[180:183], v201 offset:2112
    v_mfma_f32_16x16x32_bf16 v[28:31], v[72:75], v[124:127], v[28:31]
    ds_read_b128 v[152:155], v200 offset:2112
    v_mfma_f32_16x16x32_bf16 v[32:35], v[76:79], v[124:127], v[32:35]
    ds_read_b128 v[184:187], v201 offset:1600
    v_mfma_f32_16x16x32_bf16 v[36:39], v[80:83], v[124:127], v[36:39]
    ds_read_b128 v[156:159], v200 offset:2624
    v_mfma_f32_16x16x32_bf16 v[28:31], v[92:95], v[104:107], v[28:31]
    ds_read_b128 v[188:191], v201 offset:1088
    v_mfma_f32_16x16x32_bf16 v[32:35], v[92:95], v[108:111], v[32:35]
    ds_read_b128 v[160:163], v200 offset:3136
    v_mfma_f32_16x16x32_bf16 v[36:39], v[92:95], v[112:115], v[36:39]
    ds_read_b128 v[192:195], v201 offset:576
    v_mfma_f32_16x16x32_bf16 v[32:35], v[72:75], v[128:131], v[32:35]
    ds_read_b128 v[164:167], v200 offset:3648
    v_mfma_f32_16x16x32_bf16 v[36:39], v[76:79], v[128:131], v[36:39]
    ds_read_b128 v[196:199], v201 offset:64
    v_mfma_f32_16x16x32_bf16 v[32:35], v[96:99], v[104:107], v[32:35]
    v_mfma_f32_16x16x32_bf16 v[36:39], v[96:99], v[108:111], v[36:39]
    v_mfma_f32_16x16x32_bf16 v[36:39], v[72:75], v[132:135], v[36:39]
    v_mfma_f32_16x16x32_bf16 v[36:39], v[100:103], v[104:107], v[36:39]
    s_waitcnt lgkmcnt(0)
    v_mfma_f32_16x16x32_bf16 v[8:11], v[136:139], v[168:171], v[8:11]
    ds_read_b128 v[72:75], v200 offset:128
    v_mfma_f32_16x16x32_bf16 v[12:15], v[136:139], v[172:175], v[12:15]
    ds_read_b128 v[104:107], v201 offset:3712
    v_mfma_f32_16x16x32_bf16 v[12:15], v[140:143], v[168:171], v[12:15]
    ds_read_b128 v[76:79], v200 offset:640
    v_mfma_f32_16x16x32_bf16 v[16:19], v[136:139], v[176:179], v[16:19]
    ds_read_b128 v[108:111], v201 offset:3200
    v_mfma_f32_16x16x32_bf16 v[16:19], v[140:143], v[172:175], v[16:19]
    ds_read_b128 v[80:83], v200 offset:1152
    v_mfma_f32_16x16x32_bf16 v[16:19], v[144:147], v[168:171], v[16:19]
    ds_read_b128 v[112:115], v201 offset:2688
    v_mfma_f32_16x16x32_bf16 v[20:23], v[136:139], v[180:183], v[20:23]
    ds_read_b128 v[84:87], v200 offset:1664
    v_mfma_f32_16x16x32_bf16 v[20:23], v[140:143], v[176:179], v[20:23]
    ds_read_b128 v[116:119], v201 offset:2176
    v_mfma_f32_16x16x32_bf16 v[20:23], v[144:147], v[172:175], v[20:23]
    ds_read_b128 v[88:91], v200 offset:2176
    v_mfma_f32_16x16x32_bf16 v[20:23], v[148:151], v[168:171], v[20:23]
    ds_read_b128 v[120:123], v201 offset:1664
    v_mfma_f32_16x16x32_bf16 v[24:27], v[136:139], v[184:187], v[24:27]
    ds_read_b128 v[92:95], v200 offset:2688
    v_mfma_f32_16x16x32_bf16 v[24:27], v[140:143], v[180:183], v[24:27]
    ds_read_b128 v[124:127], v201 offset:1152
    v_mfma_f32_16x16x32_bf16 v[24:27], v[144:147], v[176:179], v[24:27]
    ds_read_b128 v[96:99], v200 offset:3200
    v_mfma_f32_16x16x32_bf16 v[24:27], v[148:151], v[172:175], v[24:27]
    ds_read_b128 v[128:131], v201 offset:640
    v_mfma_f32_16x16x32_bf16 v[24:27], v[152:155], v[168:171], v[24:27]
    ds_read_b128 v[100:103], v200 offset:3712
    v_mfma_f32_16x16x32_bf16 v[28:31], v[136:139], v[188:191], v[28:31]
    ds_read_b128 v[132:135], v201 offset:128
    v_mfma_f32_16x16x32_bf16 v[28:31], v[140:143], v[184:187], v[28:31]
    buffer_load_dwordx2 v[208:209], v229, s[48:51], 0 offen offset:0
    v_mfma_f32_16x16x32_bf16 v[28:31], v[144:147], v[180:183], v[28:31]
    buffer_load_dwordx2 v[210:211], v229, s[48:51], 0 offen offset:1280
    v_mfma_f32_16x16x32_bf16 v[28:31], v[148:151], v[176:179], v[28:31]
    buffer_load_dwordx2 v[212:213], v229, s[48:51], 0 offen offset:2560
    v_mfma_f32_16x16x32_bf16 v[28:31], v[152:155], v[172:175], v[28:31]
    buffer_load_dwordx2 v[214:215], v229, s[48:51], 0 offen offset:3840
    v_mfma_f32_16x16x32_bf16 v[28:31], v[156:159], v[168:171], v[28:31]
    buffer_load_dwordx2 v[216:217], v228, s[48:51], 0 offen offset:0
    v_mfma_f32_16x16x32_bf16 v[32:35], v[136:139], v[192:195], v[32:35]
    buffer_load_dwordx2 v[218:219], v228, s[48:51], 0 offen offset:1280
    v_mfma_f32_16x16x32_bf16 v[32:35], v[140:143], v[188:191], v[32:35]
    buffer_load_dwordx2 v[220:221], v228, s[48:51], 0 offen offset:2560
    v_mfma_f32_16x16x32_bf16 v[32:35], v[144:147], v[184:187], v[32:35]
    buffer_load_dwordx2 v[222:223], v228, s[48:51], 0 offen offset:3840
    v_mfma_f32_16x16x32_bf16 v[32:35], v[148:151], v[180:183], v[32:35]
    v_mfma_f32_16x16x32_bf16 v[32:35], v[152:155], v[176:179], v[32:35]
    v_mfma_f32_16x16x32_bf16 v[32:35], v[156:159], v[172:175], v[32:35]
    v_mfma_f32_16x16x32_bf16 v[32:35], v[160:163], v[168:171], v[32:35]
    v_mfma_f32_16x16x32_bf16 v[36:39], v[136:139], v[196:199], v[36:39]
    v_mfma_f32_16x16x32_bf16 v[36:39], v[140:143], v[192:195], v[36:39]
    v_mfma_f32_16x16x32_bf16 v[36:39], v[144:147], v[188:191], v[36:39]
    v_mfma_f32_16x16x32_bf16 v[36:39], v[148:151], v[184:187], v[36:39]
    v_mfma_f32_16x16x32_bf16 v[36:39], v[152:155], v[180:183], v[36:39]
    v_mfma_f32_16x16x32_bf16 v[36:39], v[156:159], v[176:179], v[36:39]
    v_mfma_f32_16x16x32_bf16 v[36:39], v[160:163], v[172:175], v[36:39]
    v_mfma_f32_16x16x32_bf16 v[36:39], v[164:167], v[168:171], v[36:39]
    s_waitcnt lgkmcnt(0)
    v_mfma_f32_16x16x32_bf16 v[8:11], v[72:75], v[104:107], v[8:11]
    ds_read_b128 v[136:139], v200 offset:192
    v_mfma_f32_16x16x32_bf16 v[12:15], v[72:75], v[108:111], v[12:15]
    v_mfma_f32_16x16x32_bf16 v[12:15], v[76:79], v[104:107], v[12:15]
    ds_read_b128 v[168:171], v201 offset:3776
    v_mfma_f32_16x16x32_bf16 v[16:19], v[72:75], v[112:115], v[16:19]
    v_mfma_f32_16x16x32_bf16 v[16:19], v[76:79], v[108:111], v[16:19]
    ds_read_b128 v[140:143], v200 offset:704
    v_mfma_f32_16x16x32_bf16 v[16:19], v[80:83], v[104:107], v[16:19]
    v_mfma_f32_16x16x32_bf16 v[20:23], v[72:75], v[116:119], v[20:23]
    ds_read_b128 v[172:175], v201 offset:3264
    v_mfma_f32_16x16x32_bf16 v[20:23], v[76:79], v[112:115], v[20:23]
    v_mfma_f32_16x16x32_bf16 v[20:23], v[80:83], v[108:111], v[20:23]
    ds_read_b128 v[144:147], v200 offset:1216
    v_mfma_f32_16x16x32_bf16 v[20:23], v[84:87], v[104:107], v[20:23]
    v_mfma_f32_16x16x32_bf16 v[24:27], v[72:75], v[120:123], v[24:27]
    ds_read_b128 v[176:179], v201 offset:2752
    v_mfma_f32_16x16x32_bf16 v[24:27], v[76:79], v[116:119], v[24:27]
    v_mfma_f32_16x16x32_bf16 v[24:27], v[80:83], v[112:115], v[24:27]
    ds_read_b128 v[148:151], v200 offset:1728
    v_mfma_f32_16x16x32_bf16 v[24:27], v[84:87], v[108:111], v[24:27]
    v_mfma_f32_16x16x32_bf16 v[24:27], v[88:91], v[104:107], v[24:27]
    ds_read_b128 v[180:183], v201 offset:2240
    v_mfma_f32_16x16x32_bf16 v[28:31], v[72:75], v[124:127], v[28:31]
    v_mfma_f32_16x16x32_bf16 v[28:31], v[76:79], v[120:123], v[28:31]
    ds_read_b128 v[152:155], v200 offset:2240
    v_mfma_f32_16x16x32_bf16 v[28:31], v[80:83], v[116:119], v[28:31]
    v_mfma_f32_16x16x32_bf16 v[28:31], v[84:87], v[112:115], v[28:31]
    ds_read_b128 v[184:187], v201 offset:1728
    v_mfma_f32_16x16x32_bf16 v[28:31], v[88:91], v[108:111], v[28:31]
    v_mfma_f32_16x16x32_bf16 v[28:31], v[92:95], v[104:107], v[28:31]
    ds_read_b128 v[156:159], v200 offset:2752
    v_mfma_f32_16x16x32_bf16 v[32:35], v[72:75], v[128:131], v[32:35]
    v_mfma_f32_16x16x32_bf16 v[32:35], v[76:79], v[124:127], v[32:35]
    ds_read_b128 v[188:191], v201 offset:1216
    v_mfma_f32_16x16x32_bf16 v[32:35], v[80:83], v[120:123], v[32:35]
    v_mfma_f32_16x16x32_bf16 v[32:35], v[84:87], v[116:119], v[32:35]
    ds_read_b128 v[160:163], v200 offset:3264
    v_mfma_f32_16x16x32_bf16 v[32:35], v[88:91], v[112:115], v[32:35]
    v_mfma_f32_16x16x32_bf16 v[32:35], v[92:95], v[108:111], v[32:35]
    ds_read_b128 v[192:195], v201 offset:704
    v_mfma_f32_16x16x32_bf16 v[32:35], v[96:99], v[104:107], v[32:35]
    v_mfma_f32_16x16x32_bf16 v[36:39], v[72:75], v[132:135], v[36:39]
    ds_read_b128 v[164:167], v200 offset:3776
    v_mfma_f32_16x16x32_bf16 v[36:39], v[76:79], v[128:131], v[36:39]
    v_mfma_f32_16x16x32_bf16 v[36:39], v[80:83], v[124:127], v[36:39]
    ds_read_b128 v[196:199], v201 offset:192
    v_mfma_f32_16x16x32_bf16 v[36:39], v[84:87], v[120:123], v[36:39]
    v_mfma_f32_16x16x32_bf16 v[36:39], v[88:91], v[116:119], v[36:39]
    v_mfma_f32_16x16x32_bf16 v[36:39], v[92:95], v[112:115], v[36:39]
    v_mfma_f32_16x16x32_bf16 v[36:39], v[96:99], v[108:111], v[36:39]
    v_mfma_f32_16x16x32_bf16 v[36:39], v[100:103], v[104:107], v[36:39]
    s_waitcnt lgkmcnt(0)
    v_mfma_f32_16x16x32_bf16 v[8:11], v[136:139], v[168:171], v[8:11]
    ds_read_b128 v[72:75], v200 offset:256
    v_mfma_f32_16x16x32_bf16 v[12:15], v[136:139], v[172:175], v[12:15]
    v_mfma_f32_16x16x32_bf16 v[12:15], v[140:143], v[168:171], v[12:15]
    ds_read_b128 v[104:107], v201 offset:3840
    v_mfma_f32_16x16x32_bf16 v[16:19], v[136:139], v[176:179], v[16:19]
    v_mfma_f32_16x16x32_bf16 v[16:19], v[140:143], v[172:175], v[16:19]
    ds_read_b128 v[76:79], v200 offset:768
    v_mfma_f32_16x16x32_bf16 v[16:19], v[144:147], v[168:171], v[16:19]
    v_mfma_f32_16x16x32_bf16 v[20:23], v[136:139], v[180:183], v[20:23]
    ds_read_b128 v[108:111], v201 offset:3328
    v_mfma_f32_16x16x32_bf16 v[20:23], v[140:143], v[176:179], v[20:23]
    v_mfma_f32_16x16x32_bf16 v[20:23], v[144:147], v[172:175], v[20:23]
    ds_read_b128 v[80:83], v200 offset:1280
    v_mfma_f32_16x16x32_bf16 v[20:23], v[148:151], v[168:171], v[20:23]
    v_mfma_f32_16x16x32_bf16 v[24:27], v[136:139], v[184:187], v[24:27]
    ds_read_b128 v[112:115], v201 offset:2816
    v_mfma_f32_16x16x32_bf16 v[24:27], v[140:143], v[180:183], v[24:27]
    v_mfma_f32_16x16x32_bf16 v[24:27], v[144:147], v[176:179], v[24:27]
    ds_read_b128 v[84:87], v200 offset:1792
    v_mfma_f32_16x16x32_bf16 v[24:27], v[148:151], v[172:175], v[24:27]
    v_mfma_f32_16x16x32_bf16 v[24:27], v[152:155], v[168:171], v[24:27]
    ds_read_b128 v[116:119], v201 offset:2304
    v_mfma_f32_16x16x32_bf16 v[28:31], v[136:139], v[188:191], v[28:31]
    v_mfma_f32_16x16x32_bf16 v[28:31], v[140:143], v[184:187], v[28:31]
    ds_read_b128 v[88:91], v200 offset:2304
    v_mfma_f32_16x16x32_bf16 v[28:31], v[144:147], v[180:183], v[28:31]
    v_mfma_f32_16x16x32_bf16 v[28:31], v[148:151], v[176:179], v[28:31]
    ds_read_b128 v[120:123], v201 offset:1792
    v_mfma_f32_16x16x32_bf16 v[28:31], v[152:155], v[172:175], v[28:31]
    v_mfma_f32_16x16x32_bf16 v[28:31], v[156:159], v[168:171], v[28:31]
    ds_read_b128 v[92:95], v200 offset:2816
    v_mfma_f32_16x16x32_bf16 v[32:35], v[136:139], v[192:195], v[32:35]
    v_mfma_f32_16x16x32_bf16 v[32:35], v[140:143], v[188:191], v[32:35]
    ds_read_b128 v[124:127], v201 offset:1280
    v_mfma_f32_16x16x32_bf16 v[32:35], v[144:147], v[184:187], v[32:35]
    v_mfma_f32_16x16x32_bf16 v[32:35], v[148:151], v[180:183], v[32:35]
    ds_read_b128 v[96:99], v200 offset:3328
    v_mfma_f32_16x16x32_bf16 v[32:35], v[152:155], v[176:179], v[32:35]
    v_mfma_f32_16x16x32_bf16 v[32:35], v[156:159], v[172:175], v[32:35]
    ds_read_b128 v[128:131], v201 offset:768
    v_mfma_f32_16x16x32_bf16 v[32:35], v[160:163], v[168:171], v[32:35]
    v_mfma_f32_16x16x32_bf16 v[36:39], v[136:139], v[196:199], v[36:39]
    ds_read_b128 v[100:103], v200 offset:3840
    v_mfma_f32_16x16x32_bf16 v[36:39], v[140:143], v[192:195], v[36:39]
    v_mfma_f32_16x16x32_bf16 v[36:39], v[144:147], v[188:191], v[36:39]
    ds_read_b128 v[132:135], v201 offset:256
    v_mfma_f32_16x16x32_bf16 v[36:39], v[148:151], v[184:187], v[36:39]
    v_mfma_f32_16x16x32_bf16 v[36:39], v[152:155], v[180:183], v[36:39]
    v_mfma_f32_16x16x32_bf16 v[36:39], v[156:159], v[176:179], v[36:39]
    v_mfma_f32_16x16x32_bf16 v[36:39], v[160:163], v[172:175], v[36:39]
    v_mfma_f32_16x16x32_bf16 v[36:39], v[164:167], v[168:171], v[36:39]
    v_mov_b32 v250, 163796
    s_waitcnt lgkmcnt(0)
    v_mfma_f32_16x16x32_bf16 v[8:11], v[72:75], v[104:107], v[8:11]
    ds_read_b128 v[136:139], v200 offset:320
    v_mfma_f32_16x16x32_bf16 v[12:15], v[72:75], v[108:111], v[12:15]
    v_mfma_f32_16x16x32_bf16 v[12:15], v[76:79], v[104:107], v[12:15]
    ds_read_b128 v[168:171], v201 offset:3904
    v_mfma_f32_16x16x32_bf16 v[16:19], v[72:75], v[112:115], v[16:19]
    v_mfma_f32_16x16x32_bf16 v[16:19], v[76:79], v[108:111], v[16:19]
    ds_read_b128 v[140:143], v200 offset:832
    v_mfma_f32_16x16x32_bf16 v[16:19], v[80:83], v[104:107], v[16:19]
    v_mfma_f32_16x16x32_bf16 v[20:23], v[72:75], v[116:119], v[20:23]
    ds_read_b128 v[172:175], v201 offset:3392
    v_mfma_f32_16x16x32_bf16 v[20:23], v[76:79], v[112:115], v[20:23]
    v_mfma_f32_16x16x32_bf16 v[20:23], v[80:83], v[108:111], v[20:23]
    ds_read_b128 v[144:147], v200 offset:1344
    v_mfma_f32_16x16x32_bf16 v[20:23], v[84:87], v[104:107], v[20:23]
    v_mfma_f32_16x16x32_bf16 v[24:27], v[72:75], v[120:123], v[24:27]
    ds_read_b128 v[176:179], v201 offset:2880
    v_mfma_f32_16x16x32_bf16 v[24:27], v[76:79], v[116:119], v[24:27]
    v_mfma_f32_16x16x32_bf16 v[24:27], v[80:83], v[112:115], v[24:27]
    ds_read_b128 v[148:151], v200 offset:1856
    v_mfma_f32_16x16x32_bf16 v[24:27], v[84:87], v[108:111], v[24:27]
    v_mfma_f32_16x16x32_bf16 v[24:27], v[88:91], v[104:107], v[24:27]
    ds_read_b128 v[180:183], v201 offset:2368
    v_mfma_f32_16x16x32_bf16 v[28:31], v[72:75], v[124:127], v[28:31]
    v_mfma_f32_16x16x32_bf16 v[28:31], v[76:79], v[120:123], v[28:31]
    ds_read_b128 v[152:155], v200 offset:2368
    v_mfma_f32_16x16x32_bf16 v[28:31], v[80:83], v[116:119], v[28:31]
    v_mfma_f32_16x16x32_bf16 v[28:31], v[84:87], v[112:115], v[28:31]
    ds_read_b128 v[184:187], v201 offset:1856
    v_mfma_f32_16x16x32_bf16 v[28:31], v[88:91], v[108:111], v[28:31]
    v_mfma_f32_16x16x32_bf16 v[28:31], v[92:95], v[104:107], v[28:31]
    ds_read_b128 v[156:159], v200 offset:2880
    v_mfma_f32_16x16x32_bf16 v[32:35], v[72:75], v[128:131], v[32:35]
    v_mfma_f32_16x16x32_bf16 v[32:35], v[76:79], v[124:127], v[32:35]
    ds_read_b128 v[188:191], v201 offset:1344
    v_mfma_f32_16x16x32_bf16 v[32:35], v[80:83], v[120:123], v[32:35]
    v_mfma_f32_16x16x32_bf16 v[32:35], v[84:87], v[116:119], v[32:35]
    ds_read_b128 v[160:163], v200 offset:3392
    v_mfma_f32_16x16x32_bf16 v[32:35], v[88:91], v[112:115], v[32:35]
    v_mfma_f32_16x16x32_bf16 v[32:35], v[92:95], v[108:111], v[32:35]
    ds_read_b128 v[192:195], v201 offset:832
    v_mfma_f32_16x16x32_bf16 v[32:35], v[96:99], v[104:107], v[32:35]
    v_mfma_f32_16x16x32_bf16 v[36:39], v[72:75], v[132:135], v[36:39]
    ds_read_b128 v[164:167], v200 offset:3904
    v_mfma_f32_16x16x32_bf16 v[36:39], v[76:79], v[128:131], v[36:39]
    v_mfma_f32_16x16x32_bf16 v[36:39], v[80:83], v[124:127], v[36:39]
    ds_read_b128 v[196:199], v201 offset:320
    v_mfma_f32_16x16x32_bf16 v[36:39], v[84:87], v[120:123], v[36:39]
    v_mfma_f32_16x16x32_bf16 v[36:39], v[88:91], v[116:119], v[36:39]
    ds_read_b32 v247, v250
    v_mfma_f32_16x16x32_bf16 v[36:39], v[92:95], v[112:115], v[36:39]
    v_mfma_f32_16x16x32_bf16 v[36:39], v[96:99], v[108:111], v[36:39]
    v_mfma_f32_16x16x32_bf16 v[36:39], v[100:103], v[104:107], v[36:39]
    s_waitcnt lgkmcnt(0)
    v_readfirstlane_b32 s3, v247
    s_nop 1
    s_cmp_ge_u32 s3, 2
    s_cbranch_scc1 L_r42750
    v_mov_b32 v250, 163796
    s_mov_b32 s4, 0
L_go2753:
    ds_read_b32 v247, v250
    s_add_u32 s4, s4, 1
    s_waitcnt lgkmcnt(0)
    v_readfirstlane_b32 s3, v247
    s_cmp_ge_u32 s4, 0x1000000
    s_cbranch_scc1 L_gx2753
    s_cmp_lt_u32 s3, 2
    s_cbranch_scc0 L_gx2753
    s_sleep 1
    s_branch L_go2753
L_gx2753:
L_r42750:
    v_mfma_f32_16x16x32_bf16 v[8:11], v[136:139], v[168:171], v[8:11]
    ds_read_b128 v[72:75], v202 offset:0
    v_mfma_f32_16x16x32_bf16 v[12:15], v[136:139], v[172:175], v[12:15]
    v_mfma_f32_16x16x32_bf16 v[12:15], v[140:143], v[168:171], v[12:15]
    ds_read_b128 v[104:107], v203 offset:3584
    v_mfma_f32_16x16x32_bf16 v[16:19], v[136:139], v[176:179], v[16:19]
    v_mfma_f32_16x16x32_bf16 v[16:19], v[140:143], v[172:175], v[16:19]
    ds_read_b128 v[76:79], v202 offset:512
    v_mfma_f32_16x16x32_bf16 v[16:19], v[144:147], v[168:171], v[16:19]
    v_mfma_f32_16x16x32_bf16 v[20:23], v[136:139], v[180:183], v[20:23]
    ds_read_b128 v[108:111], v203 offset:3072
    v_mfma_f32_16x16x32_bf16 v[20:23], v[140:143], v[176:179], v[20:23]
    v_mfma_f32_16x16x32_bf16 v[20:23], v[144:147], v[172:175], v[20:23]
    ds_read_b128 v[80:83], v202 offset:1024
    v_mfma_f32_16x16x32_bf16 v[20:23], v[148:151], v[168:171], v[20:23]
    v_mfma_f32_16x16x32_bf16 v[24:27], v[136:139], v[184:187], v[24:27]
    ds_read_b128 v[112:115], v203 offset:2560
    v_mfma_f32_16x16x32_bf16 v[24:27], v[140:143], v[180:183], v[24:27]
    v_mfma_f32_16x16x32_bf16 v[24:27], v[144:147], v[176:179], v[24:27]
    ds_read_b128 v[84:87], v202 offset:1536
    v_mfma_f32_16x16x32_bf16 v[24:27], v[148:151], v[172:175], v[24:27]
    v_mfma_f32_16x16x32_bf16 v[24:27], v[152:155], v[168:171], v[24:27]
    ds_read_b128 v[116:119], v203 offset:2048
    v_mfma_f32_16x16x32_bf16 v[28:31], v[136:139], v[188:191], v[28:31]
    v_mfma_f32_16x16x32_bf16 v[28:31], v[140:143], v[184:187], v[28:31]
    ds_read_b128 v[88:91], v202 offset:2048
    v_mfma_f32_16x16x32_bf16 v[28:31], v[144:147], v[180:183], v[28:31]
    v_mfma_f32_16x16x32_bf16 v[28:31], v[148:151], v[176:179], v[28:31]
    ds_read_b128 v[120:123], v203 offset:1536
    v_mfma_f32_16x16x32_bf16 v[28:31], v[152:155], v[172:175], v[28:31]
    v_mfma_f32_16x16x32_bf16 v[28:31], v[156:159], v[168:171], v[28:31]
    ds_read_b128 v[92:95], v202 offset:2560
    v_mfma_f32_16x16x32_bf16 v[32:35], v[136:139], v[192:195], v[32:35]
    v_mfma_f32_16x16x32_bf16 v[32:35], v[140:143], v[188:191], v[32:35]
    ds_read_b128 v[124:127], v203 offset:1024
    v_mfma_f32_16x16x32_bf16 v[32:35], v[144:147], v[184:187], v[32:35]
    v_mfma_f32_16x16x32_bf16 v[32:35], v[148:151], v[180:183], v[32:35]
    ds_read_b128 v[96:99], v202 offset:3072
    v_mfma_f32_16x16x32_bf16 v[32:35], v[152:155], v[176:179], v[32:35]
    v_mfma_f32_16x16x32_bf16 v[32:35], v[156:159], v[172:175], v[32:35]
    ds_read_b128 v[128:131], v203 offset:512
    v_mfma_f32_16x16x32_bf16 v[32:35], v[160:163], v[168:171], v[32:35]
    v_mfma_f32_16x16x32_bf16 v[36:39], v[136:139], v[196:199], v[36:39]
    ds_read_b128 v[100:103], v202 offset:3584
    v_mfma_f32_16x16x32_bf16 v[36:39], v[140:143], v[192:195], v[36:39]
    v_mfma_f32_16x16x32_bf16 v[36:39], v[144:147], v[188:191], v[36:39]
    ds_read_b128 v[132:135], v203 offset:0
    v_mfma_f32_16x16x32_bf16 v[36:39], v[148:151], v[184:187], v[36:39]
    v_mfma_f32_16x16x32_bf16 v[36:39], v[152:155], v[180:183], v[36:39]
    v_mfma_f32_16x16x32_bf16 v[36:39], v[156:159], v[176:179], v[36:39]
    v_mfma_f32_16x16x32_bf16 v[36:39], v[160:163], v[172:175], v[36:39]
    v_mfma_f32_16x16x32_bf16 v[36:39], v[164:167], v[168:171], v[36:39]
    s_waitcnt lgkmcnt(0)
    v_mfma_f32_16x16x32_bf16 v[40:43], v[72:75], v[104:107], 0
    ds_read_b128 v[136:139], v202 offset:64
    v_mfma_f32_16x16x32_bf16 v[44:47], v[72:75], v[108:111], 0
    v_mfma_f32_16x16x32_bf16 v[44:47], v[76:79], v[104:107], v[44:47]
    ds_read_b128 v[168:171], v203 offset:3648
    v_mfma_f32_16x16x32_bf16 v[48:51], v[72:75], v[112:115], 0
    v_mfma_f32_16x16x32_bf16 v[48:51], v[76:79], v[108:111], v[48:51]
    ds_read_b128 v[140:143], v202 offset:576
    v_mfma_f32_16x16x32_bf16 v[48:51], v[80:83], v[104:107], v[48:51]
    v_mfma_f32_16x16x32_bf16 v[52:55], v[72:75], v[116:119], 0
    ds_read_b128 v[172:175], v203 offset:3136
    v_mfma_f32_16x16x32_bf16 v[52:55], v[76:79], v[112:115], v[52:55]
    v_mfma_f32_16x16x32_bf16 v[52:55], v[80:83], v[108:111], v[52:55]
    ds_read_b128 v[144:147], v202 offset:1088
    v_mfma_f32_16x16x32_bf16 v[52:55], v[84:87], v[104:107], v[52:55]
    v_mfma_f32_16x16x32_bf16 v[56:59], v[72:75], v[120:123], 0
    ds_read_b128 v[176:179], v203 offset:2624
    v_mfma_f32_16x16x32_bf16 v[56:59], v[76:79], v[116:119], v[56:59]
    v_mfma_f32_16x16x32_bf16 v[56:59], v[80:83], v[112:115], v[56:59]
    ds_read_b128 v[148:151], v202 offset:1600
    v_mfma_f32_16x16x32_bf16 v[56:59], v[84:87], v[108:111], v[56:59]
    v_mfma_f32_16x16x32_bf16 v[56:59], v[88:91], v[104:107], v[56:59]
    ds_read_b128 v[180:183], v203 offset:2112
    v_mfma_f32_16x16x32_bf16 v[60:63], v[72:75], v[124:127], 0
    v_mfma_f32_16x16x32_bf16 v[60:63], v[76:79], v[120:123], v[60:63]
    ds_read_b128 v[152:155], v202 offset:2112
    v_mfma_f32_16x16x32_bf16 v[60:63], v[80:83], v[116:119], v[60:63]
    v_mfma_f32_16x16x32_bf16 v[60:63], v[84:87], v[112:115], v[60:63]
    ds_read_b128 v[184:187], v203 offset:1600
    v_mfma_f32_16x16x32_bf16 v[60:63], v[88:91], v[108:111], v[60:63]
    v_mfma_f32_16x16x32_bf16 v[60:63], v[92:95], v[104:107], v[60:63]
    ds_read_b128 v[156:159], v202 offset:2624
    v_mfma_f32_16x16x32_bf16 v[64:67], v[72:75], v[128:131], 0
    v_mfma_f32_16x16x32_bf16 v[64:67], v[76:79], v[124:127], v[64:67]
    ds_read_b128 v[188:191], v203 offset:1088
    v_mfma_f32_16x16x32_bf16 v[64:67], v[80:83], v[120:123], v[64:67]
    v_mfma_f32_16x16x32_bf16 v[64:67], v[84:87], v[116:119], v[64:67]
    ds_read_b128 v[160:163], v202 offset:3136
    v_mfma_f32_16x16x32_bf16 v[64:67], v[88:91], v[112:115], v[64:67]
    v_mfma_f32_16x16x32_bf16 v[64:67], v[92:95], v[108:111], v[64:67]
    ds_read_b128 v[192:195], v203 offset:576
    v_mfma_f32_16x16x32_bf16 v[64:67], v[96:99], v[104:107], v[64:67]
    v_mfma_f32_16x16x32_bf16 v[68:71], v[72:75], v[132:135], 0
    ds_read_b128 v[164:167], v202 offset:3648
    v_mfma_f32_16x16x32_bf16 v[68:71], v[76:79], v[128:131], v[68:71]
    v_mfma_f32_16x16x32_bf16 v[68:71], v[80:83], v[124:127], v[68:71]
    ds_read_b128 v[196:199], v203 offset:64
    v_mfma_f32_16x16x32_bf16 v[68:71], v[84:87], v[120:123], v[68:71]
    v_mfma_f32_16x16x32_bf16 v[68:71], v[88:91], v[116:119], v[68:71]
    v_mfma_f32_16x16x32_bf16 v[68:71], v[92:95], v[112:115], v[68:71]
    v_mfma_f32_16x16x32_bf16 v[68:71], v[96:99], v[108:111], v[68:71]
    v_mfma_f32_16x16x32_bf16 v[68:71], v[100:103], v[104:107], v[68:71]
    s_waitcnt lgkmcnt(0)
    v_mfma_f32_16x16x32_bf16 v[40:43], v[136:139], v[168:171], v[40:43]
    ds_read_b128 v[72:75], v200 offset:384
    v_mfma_f32_16x16x32_bf16 v[44:47], v[136:139], v[172:175], v[44:47]
    v_mfma_f32_16x16x32_bf16 v[44:47], v[140:143], v[168:171], v[44:47]
    ds_read_b128 v[104:107], v201 offset:3968
    v_mfma_f32_16x16x32_bf16 v[48:51], v[136:139], v[176:179], v[48:51]
    v_mfma_f32_16x16x32_bf16 v[48:51], v[140:143], v[172:175], v[48:51]
    ds_read_b128 v[76:79], v200 offset:896
    v_mfma_f32_16x16x32_bf16 v[48:51], v[144:147], v[168:171], v[48:51]
    v_mfma_f32_16x16x32_bf16 v[52:55], v[136:139], v[180:183], v[52:55]
    ds_read_b128 v[108:111], v201 offset:3456
    v_mfma_f32_16x16x32_bf16 v[52:55], v[140:143], v[176:179], v[52:55]
    v_mfma_f32_16x16x32_bf16 v[52:55], v[144:147], v[172:175], v[52:55]
    ds_read_b128 v[80:83], v200 offset:1408
    v_mfma_f32_16x16x32_bf16 v[52:55], v[148:151], v[168:171], v[52:55]
    v_mfma_f32_16x16x32_bf16 v[56:59], v[136:139], v[184:187], v[56:59]
    ds_read_b128 v[112:115], v201 offset:2944
    v_mfma_f32_16x16x32_bf16 v[56:59], v[140:143], v[180:183], v[56:59]
    v_mfma_f32_16x16x32_bf16 v[56:59], v[144:147], v[176:179], v[56:59]
    ds_read_b128 v[84:87], v200 offset:1920
    v_mfma_f32_16x16x32_bf16 v[56:59], v[148:151], v[172:175], v[56:59]
    v_mfma_f32_16x16x32_bf16 v[56:59], v[152:155], v[168:171], v[56:59]
    ds_read_b128 v[116:119], v201 offset:2432
    v_mfma_f32_16x16x32_bf16 v[60:63], v[136:139], v[188:191], v[60:63]
    v_mfma_f32_16x16x32_bf16 v[60:63], v[140:143], v[184:187], v[60:63]
    ds_read_b128 v[88:91], v200 offset:2432
    v_mfma_f32_16x16x32_bf16 v[60:63], v[144:147], v[180:183], v[60:63]
    v_mfma_f32_16x16x32_bf16 v[60:63], v[148:151], v[176:179], v[60:63]
    ds_read_b128 v[120:123], v201 offset:1920
    v_mfma_f32_16x16x32_bf16 v[60:63], v[152:155], v[172:175], v[60:63]
    v_mfma_f32_16x16x32_bf16 v[60:63], v[156:159], v[168:171], v[60:63]
    ds_read_b128 v[92:95], v200 offset:2944
    v_mfma_f32_16x16x32_bf16 v[64:67], v[136:139], v[192:195], v[64:67]
    v_mfma_f32_16x16x32_bf16 v[64:67], v[140:143], v[188:191], v[64:67]
    ds_read_b128 v[124:127], v201 offset:1408
    v_mfma_f32_16x16x32_bf16 v[64:67], v[144:147], v[184:187], v[64:67]
    v_mfma_f32_16x16x32_bf16 v[64:67], v[148:151], v[180:183], v[64:67]
    ds_read_b128 v[96:99], v200 offset:3456
    v_mfma_f32_16x16x32_bf16 v[64:67], v[152:155], v[176:179], v[64:67]
    v_mfma_f32_16x16x32_bf16 v[64:67], v[156:159], v[172:175], v[64:67]
    ds_read_b128 v[128:131], v201 offset:896
    v_mfma_f32_16x16x32_bf16 v[64:67], v[160:163], v[168:171], v[64:67]
    v_mfma_f32_16x16x32_bf16 v[68:71], v[136:139], v[196:199], v[68:71]
    ds_read_b128 v[100:103], v200 offset:3968
    v_mfma_f32_16x16x32_bf16 v[68:71], v[140:143], v[192:195], v[68:71]
    v_mfma_f32_16x16x32_bf16 v[68:71], v[144:147], v[188:191], v[68:71]
    ds_read_b128 v[132:135], v201 offset:384
    v_mfma_f32_16x16x32_bf16 v[68:71], v[148:151], v[184:187], v[68:71]
    v_mfma_f32_16x16x32_bf16 v[68:71], v[152:155], v[180:183], v[68:71]
    v_mfma_f32_16x16x32_bf16 v[68:71], v[156:159], v[176:179], v[68:71]
    v_mfma_f32_16x16x32_bf16 v[68:71], v[160:163], v[172:175], v[68:71]
    v_mfma_f32_16x16x32_bf16 v[68:71], v[164:167], v[168:171], v[68:71]
    s_waitcnt lgkmcnt(0)
    v_mfma_f32_16x16x32_bf16 v[8:11], v[72:75], v[104:107], v[8:11]
    ds_read_b128 v[136:139], v200 offset:448
    v_mfma_f32_16x16x32_bf16 v[12:15], v[72:75], v[108:111], v[12:15]
    ds_read_b128 v[168:171], v201 offset:4032
    v_mfma_f32_16x16x32_bf16 v[12:15], v[76:79], v[104:107], v[12:15]
    ds_read_b128 v[140:143], v200 offset:960
    v_mfma_f32_16x16x32_bf16 v[16:19], v[72:75], v[112:115], v[16:19]
    ds_read_b128 v[172:175], v201 offset:3520
    v_mfma_f32_16x16x32_bf16 v[16:19], v[76:79], v[108:111], v[16:19]
    ds_read_b128 v[144:147], v200 offset:1472
    v_mfma_f32_16x16x32_bf16 v[16:19], v[80:83], v[104:107], v[16:19]
    ds_read_b128 v[176:179], v201 offset:3008
    v_mfma_f32_16x16x32_bf16 v[20:23], v[72:75], v[116:119], v[20:23]
    ds_read_b128 v[148:151], v200 offset:1984
    v_mfma_f32_16x16x32_bf16 v[20:23], v[76:79], v[112:115], v[20:23]
    ds_read_b128 v[180:183], v201 offset:2496
    v_mfma_f32_16x16x32_bf16 v[20:23], v[80:83], v[108:111], v[20:23]
    ds_read_b128 v[152:155], v200 offset:2496
    v_mfma_f32_16x16x32_bf16 v[20:23], v[84:87], v[104:107], v[20:23]
    ds_read_b128 v[184:187], v201 offset:1984
    v_mfma_f32_16x16x32_bf16 v[24:27], v[72:75], v[120:123], v[24:27]
    ds_read_b128 v[156:159], v200 offset:3008
    v_mfma_f32_16x16x32_bf16 v[24:27], v[76:79], v[116:119], v[24:27]
    ds_read_b128 v[188:191], v201 offset:1472
    v_mfma_f32_16x16x32_bf16 v[24:27], v[80:83], v[112:115], v[24:27]
    ds_read_b128 v[160:163], v200 offset:3520
    v_mfma_f32_16x16x32_bf16 v[24:27], v[84:87], v[108:111], v[24:27]
    ds_read_b128 v[192:195], v201 offset:960
    v_mfma_f32_16x16x32_bf16 v[24:27], v[88:91], v[104:107], v[24:27]
    ds_read_b128 v[164:167], v200 offset:4032
    v_mfma_f32_16x16x32_bf16 v[28:31], v[72:75], v[124:127], v[28:31]
    ds_read_b128 v[196:199], v201 offset:448
    v_mfma_f32_16x16x32_bf16 v[28:31], v[76:79], v[120:123], v[28:31]
    ds_write_b128 v246, v[40:43] offset:0
    v_mfma_f32_16x16x32_bf16 v[28:31], v[80:83], v[116:119], v[28:31]
    ds_write_b128 v246, v[44:47] offset:1024
    v_mfma_f32_16x16x32_bf16 v[28:31], v[84:87], v[112:115], v[28:31]
    ds_write_b128 v246, v[48:51] offset:2048
    v_mfma_f32_16x16x32_bf16 v[28:31], v[88:91], v[108:111], v[28:31]
    ds_write_b128 v246, v[52:55] offset:3072
    v_mfma_f32_16x16x32_bf16 v[28:31], v[92:95], v[104:107], v[28:31]
    ds_write_b128 v246, v[56:59] offset:4096
    v_mfma_f32_16x16x32_bf16 v[32:35], v[72:75], v[128:131], v[32:35]
    ds_write_b128 v246, v[60:63] offset:5120
    v_mfma_f32_16x16x32_bf16 v[32:35], v[76:79], v[124:127], v[32:35]
    ds_write_b128 v246, v[64:67] offset:6144
    v_mfma_f32_16x16x32_bf16 v[32:35], v[80:83], v[120:123], v[32:35]
    ds_write_b128 v246, v[68:71] offset:7168
    v_mfma_f32_16x16x32_bf16 v[32:35], v[84:87], v[116:119], v[32:35]
    v_mfma_f32_16x16x32_bf16 v[32:35], v[88:91], v[112:115], v[32:35]
    v_mfma_f32_16x16x32_bf16 v[32:35], v[92:95], v[108:111], v[32:35]
    v_mfma_f32_16x16x32_bf16 v[32:35], v[96:99], v[104:107], v[32:35]
    v_mfma_f32_16x16x32_bf16 v[36:39], v[72:75], v[132:135], v[36:39]
    v_mfma_f32_16x16x32_bf16 v[36:39], v[76:79], v[128:131], v[36:39]
    v_mfma_f32_16x16x32_bf16 v[36:39], v[80:83], v[124:127], v[36:39]
    v_mfma_f32_16x16x32_bf16 v[36:39], v[84:87], v[120:123], v[36:39]
    v_mfma_f32_16x16x32_bf16 v[36:39], v[88:91], v[116:119], v[36:39]
    v_mfma_f32_16x16x32_bf16 v[36:39], v[92:95], v[112:115], v[36:39]
    v_mfma_f32_16x16x32_bf16 v[36:39], v[96:99], v[108:111], v[36:39]
    v_mfma_f32_16x16x32_bf16 v[36:39], v[100:103], v[104:107], v[36:39]
    s_waitcnt lgkmcnt(0)
    v_mov_b32 v250, 163836
    v_mov_b32 v247, 1
    s_mov_b64 exec, 1
    ds_add_u32 v250, v247
    s_mov_b64 exec, -1
    v_mfma_f32_16x16x32_bf16 v[36:39], v[136:139], v[196:199], v[36:39]
    v_mfma_f32_16x16x32_bf16 v[36:39], v[140:143], v[192:195], v[36:39]
    v_mfma_f32_16x16x32_bf16 v[36:39], v[144:147], v[188:191], v[36:39]
    v_mfma_f32_16x16x32_bf16 v[36:39], v[148:151], v[184:187], v[36:39]
    v_mfma_f32_16x16x32_bf16 v[36:39], v[152:155], v[180:183], v[36:39]
    v_mfma_f32_16x16x32_bf16 v[36:39], v[156:159], v[176:179], v[36:39]
    v_mfma_f32_16x16x32_bf16 v[36:39], v[160:163], v[172:175], v[36:39]
    v_mfma_f32_16x16x32_bf16 v[36:39], v[164:167], v[168:171], v[36:39]
    v_mfma_f32_16x16x32_bf16 v[32:35], v[136:139], v[192:195], v[32:35]
    v_mfma_f32_16x16x32_bf16 v[32:35], v[140:143], v[188:191], v[32:35]
    v_mfma_f32_16x16x32_bf16 v[32:35], v[144:147], v[184:187], v[32:35]
    v_mfma_f32_16x16x32_bf16 v[32:35], v[148:151], v[180:183], v[32:35]
    v_mfma_f32_16x16x32_bf16 v[32:35], v[152:155], v[176:179], v[32:35]
    v_mfma_f32_16x16x32_bf16 v[32:35], v[156:159], v[172:175], v[32:35]
    v_mfma_f32_16x16x32_bf16 v[32:35], v[160:163], v[168:171], v[32:35]
    v_mfma_f32_16x16x32_bf16 v[28:31], v[136:139], v[188:191], v[28:31]
    v_mfma_f32_16x16x32_bf16 v[28:31], v[140:143], v[184:187], v[28:31]
    v_mfma_f32_16x16x32_bf16 v[28:31], v[144:147], v[180:183], v[28:31]
    v_mfma_f32_16x16x32_bf16 v[28:31], v[148:151], v[176:179], v[28:31]
    v_mfma_f32_16x16x32_bf16 v[28:31], v[152:155], v[172:175], v[28:31]
    v_mfma_f32_16x16x32_bf16 v[28:31], v[156:159], v[168:171], v[28:31]
    v_cvt_pk_bf16_f32 v54, v36, v37
    v_cvt_pk_bf16_f32 v55, v38, v39
    buffer_store_dwordx2 v[54:55], v248, s[52:55], s79 offen offset:3584
    v_mfma_f32_16x16x32_bf16 v[24:27], v[136:139], v[184:187], v[24:27]
    v_mfma_f32_16x16x32_bf16 v[24:27], v[140:143], v[180:183], v[24:27]
    v_mfma_f32_16x16x32_bf16 v[24:27], v[144:147], v[176:179], v[24:27]
    v_mfma_f32_16x16x32_bf16 v[24:27], v[148:151], v[172:175], v[24:27]
    v_mfma_f32_16x16x32_bf16 v[24:27], v[152:155], v[168:171], v[24:27]
    v_cvt_pk_bf16_f32 v52, v32, v33
    v_cvt_pk_bf16_f32 v53, v34, v35
    buffer_store_dwordx2 v[52:53], v248, s[52:55], s79 offen offset:3072
    v_mfma_f32_16x16x32_bf16 v[20:23], v[136:139], v[180:183], v[20:23]
    v_mfma_f32_16x16x32_bf16 v[20:23], v[140:143], v[176:179], v[20:23]
    v_mfma_f32_16x16x32_bf16 v[20:23], v[144:147], v[172:175], v[20:23]
    v_mfma_f32_16x16x32_bf16 v[20:23], v[148:151], v[168:171], v[20:23]
    v_cvt_pk_bf16_f32 v50, v28, v29
    v_cvt_pk_bf16_f32 v51, v30, v31
    buffer_store_dwordx2 v[50:51], v248, s[52:55], s79 offen offset:2560
    v_mfma_f32_16x16x32_bf16 v[16:19], v[136:139], v[176:179], v[16:19]
    v_mfma_f32_16x16x32_bf16 v[16:19], v[140:143], v[172:175], v[16:19]
    v_mfma_f32_16x16x32_bf16 v[16:19], v[144:147], v[168:171], v[16:19]
    v_cvt_pk_bf16_f32 v48, v24, v25
    v_cvt_pk_bf16_f32 v49, v26, v27
    buffer_store_dwordx2 v[48:49], v248, s[52:55], s79 offen offset:2048
    v_mfma_f32_16x16x32_bf16 v[12:15], v[136:139], v[172:175], v[12:15]
    v_mfma_f32_16x16x32_bf16 v[12:15], v[140:143], v[168:171], v[12:15]
    v_cvt_pk_bf16_f32 v46, v20, v21
    v_cvt_pk_bf16_f32 v47, v22, v23
    buffer_store_dwordx2 v[46:47], v248, s[52:55], s79 offen offset:1536
    v_mfma_f32_16x16x32_bf16 v[8:11], v[136:139], v[168:171], v[8:11]
    v_cvt_pk_bf16_f32 v44, v16, v17
    v_cvt_pk_bf16_f32 v45, v18, v19
    buffer_store_dwordx2 v[44:45], v248, s[52:55], s79 offen offset:1024
    s_nop 0
    v_cvt_pk_bf16_f32 v42, v12, v13
    v_cvt_pk_bf16_f32 v43, v14, v15
    buffer_store_dwordx2 v[42:43], v248, s[52:55], s79 offen offset:512
    s_nop 0
    v_cvt_pk_bf16_f32 v40, v8, v9
    v_cvt_pk_bf16_f32 v41, v10, v11
    buffer_store_dwordx2 v[40:41], v248, s[52:55], s79 offen offset:0
    s_branch L_CONVDONE
L_W4:
    buffer_load_dwordx2 v[208:209], v229, s[48:51], 0 offen offset:0
    buffer_load_dwordx2 v[210:211], v229, s[48:51], 0 offen offset:1280
    buffer_load_dwordx2 v[212:213], v229, s[48:51], 0 offen offset:2560
    buffer_load_dwordx2 v[214:215], v229, s[48:51], 0 offen offset:3840
    buffer_load_dwordx2 v[216:217], v228, s[48:51], 0 offen offset:0
    buffer_load_dwordx2 v[218:219], v228, s[48:51], 0 offen offset:1280
    buffer_load_dwordx2 v[220:221], v228, s[48:51], 0 offen offset:2560
    buffer_load_dwordx2 v[222:223], v228, s[48:51], 0 offen offset:3840
L_W5:
    s_sub_u32 s3, s70, 4
    s_lshl_b32 s4, s3, 11
    s_add_u32 s4, s4, 129600
    v_lshlrev_b32 v6, 4, v1
    v_add_u32 v6, s4, v6
    s_mul_i32 s94, s69, 5
    s_add_u32 s94, s94, 4
    s_lshl_b32 s94, s94, 12
    s_lshl_b32 s3, s3, 10
    s_add_u32 s94, s94, s3
    v_mov_b32 v250, 163836
    s_mov_b32 s4, 0
L_go3074:
    ds_read_b32 v247, v250
    s_add_u32 s4, s4, 1
    s_waitcnt lgkmcnt(0)
    v_readfirstlane_b32 s3, v247
    s_cmp_ge_u32 s4, 0x1000000
    s_cbranch_scc1 L_gx3074
    s_cmp_lt_u32 s3, 4
    s_cbranch_scc0 L_gx3074
    s_sleep 2
    s_branch L_go3074
L_gx3074:
    s_setprio 3
    ds_read_b128 v[72:75], v6 offset:0
    ds_read_b128 v[76:79], v6 offset:8192
    ds_read_b128 v[80:83], v6 offset:16384
    ds_read_b128 v[84:87], v6 offset:24576
    ds_read_b128 v[88:91], v6 offset:1024
    ds_read_b128 v[92:95], v6 offset:9216
    ds_read_b128 v[96:99], v6 offset:17408
    ds_read_b128 v[100:103], v6 offset:25600
    s_waitcnt lgkmcnt(4)
    v_pk_add_f32 v[72:73], v[72:73], v[76:77]
    v_pk_add_f32 v[80:81], v[80:81], v[84:85]
    v_pk_add_f32 v[74:75], v[74:75], v[78:79]
    v_pk_add_f32 v[82:83], v[82:83], v[86:87]
    v_pk_add_f32 v[72:73], v[72:73], v[80:81]
    v_pk_add_f32 v[74:75], v[74:75], v[82:83]
    v_cvt_pk_bf16_f32 v40, v72, v73
    v_cvt_pk_bf16_f32 v41, v74, v75
    buffer_store_dwordx2 v[40:41], v248, s[52:55], s94 offen offset:0
    s_waitcnt lgkmcnt(0)
    v_pk_add_f32 v[88:89], v[88:89], v[92:93]
    v_pk_add_f32 v[96:97], v[96:97], v[100:101]
    v_pk_add_f32 v[90:91], v[90:91], v[94:95]
    v_pk_add_f32 v[98:99], v[98:99], v[102:103]
    v_pk_add_f32 v[88:89], v[88:89], v[96:97]
    v_pk_add_f32 v[90:91], v[90:91], v[98:99]
    v_cvt_pk_bf16_f32 v42, v88, v89
    v_cvt_pk_bf16_f32 v43, v90, v91
    buffer_store_dwordx2 v[42:43], v248, s[52:55], s94 offen offset:512
    s_setprio 0
    s_cmp_eq_u32 s92, 0
    s_cbranch_scc1 L_ZOK
    buffer_store_dwordx2 v[40:41], v248, s[52:55], s94 offen offset:0 sc1
    buffer_store_dwordx2 v[42:43], v248, s[52:55], s94 offen offset:512 sc1
    s_branch L_ZOK
L_CONVDONE:
    s_cmp_eq_u32 s92, 0
    s_cbranch_scc1 L_ZOK
    buffer_store_dwordx2 v[40:41], v248, s[52:55], s79 offen offset:0 sc1
    buffer_store_dwordx2 v[42:43], v248, s[52:55], s79 offen offset:512 sc1
    buffer_store_dwordx2 v[44:45], v248, s[52:55], s79 offen offset:1024 sc1
    buffer_store_dwordx2 v[46:47], v248, s[52:55], s79 offen offset:1536 sc1
    buffer_store_dwordx2 v[48:49], v248, s[52:55], s79 offen offset:2048 sc1
    buffer_store_dwordx2 v[50:51], v248, s[52:55], s79 offen offset:2560 sc1
    buffer_store_dwordx2 v[52:53], v248, s[52:55], s79 offen offset:3072 sc1
    buffer_store_dwordx2 v[54:55], v248, s[52:55], s79 offen offset:3584 sc1
L_ZOK:
    s_waitcnt vmcnt(0)
    v_mov_b32 v250, 163832
    v_mov_b32 v247, 1
    s_mov_b64 exec, 1
    ds_add_rtn_u32 v247, v250, v247
    s_mov_b64 exec, -1
    s_waitcnt lgkmcnt(0)
    v_readfirstlane_b32 s3, v247
    s_nop 1
    s_cmp_lg_u32 s3, 7
    s_cbranch_scc1 L_zs3135
    s_lshl_b32 s75, s68, 5
    s_add_u32 s75, s75, s69
    s_mov_b64 exec, 1
    s_cmp_eq_u32 s92, 0
    s_cbranch_scc0 L_sf3145
    s_or_b32 s3, s71, 24
    v_mov_b32 v250, s75
    v_mov_b32 v247, s3
    buffer_store_byte v247, v250, s[60:63], 0 offen
    s_branch L_rf3145
L_sf3145:
    s_and_b32 s3, s75, 3
    s_lshl_b32 s3, s3, 3
    s_or_b32 s4, s71, 80
    s_lshl_b32 s4, s4, s3
    s_and_b32 s3, s75, 0xfc
    v_mov_b32 v250, s3
    v_mov_b32 v247, s4
    buffer_atomic_or v247, v250, s[60:63], 0 offen sc1
L_rf3145:
    s_mov_b64 exec, -1
L_zs3135:
    v_mul_u32_u24 v3, 1639, v0
    v_lshrrev_b32 v3, 16, v3
    v_mul_u32_u24 v2, 40, v3
    v_sub_u32 v2, v0, v2
    s_lshl_b32 s4, s69, 7
    v_lshrrev_b32 v6, 3, v0
    v_and_b32 v7, 7, v0
    v_lshlrev_b32 v10, 12, v6
    v_add_u32 v10, s4, v10
    v_add_u32 v8, 0, v6
    v_lshrrev_b32 v8, 2, v8
    v_and_b32 v8, 7, v8
    v_xor_b32 v8, v8, v7
    v_lshlrev_b32 v8, 4, v8
    v_add_u32 v240, v10, v8
    v_add_u32 v8, 40, v6
    v_lshrrev_b32 v8, 2, v8
    v_and_b32 v8, 7, v8
    v_xor_b32 v8, v8, v7
    v_lshlrev_b32 v8, 4, v8
    v_add_u32 v241, v10, v8
    v_add_u32 v8, 80, v6
    v_lshrrev_b32 v8, 2, v8
    v_and_b32 v8, 7, v8
    v_xor_b32 v8, v8, v7
    v_lshlrev_b32 v8, 4, v8
    v_add_u32 v242, v10, v8
    v_add_u32 v8, 120, v6
    v_lshrrev_b32 v8, 2, v8
    v_and_b32 v8, 7, v8
    v_xor_b32 v8, v8, v7
    v_lshlrev_b32 v8, 4, v8
    v_add_u32 v243, v10, v8
    s_lshl_b32 s96, s70, 10
    s_add_u32 s96, s96, 0
    v_and_b32 v7, 7, v2
    v_xor_b32 v14, v3, v7
    v_lshlrev_b32 v14, 4, v14
    v_lshlrev_b32 v7, 9, v2
    v_add_u32 v7, 0, v7
    v_add_u32 v14, v14, v7
    s_lshl_b32 s75, s69, 6
    v_lshlrev_b32 v12, 3, v3
    v_add_u32 v12, s75, v12
    v_mul_u32_u24 v12, 2560, v12
    s_mul_i32 s75, s72, 1280
    s_lshl_b32 s4, s73, 1
    s_add_u32 s75, s75, s4
    v_lshlrev_b32 v13, 3, v2
    v_add3_u32 v12, v12, v13, s75
    v_add_u32 v13, 10240, v12
    s_cmp_eq_u32 s72, 0
    s_cbranch_scc1 L_P3Q
    v_lshlrev_b32 v104, 16, v208
    v_and_b32 v105, s76, v208
    v_lshlrev_b32 v106, 16, v209
    v_and_b32 v107, s76, v209
    v_lshlrev_b32 v108, 16, v210
    v_and_b32 v109, s76, v210
    v_lshlrev_b32 v110, 16, v211
    v_and_b32 v111, s76, v211
    v_lshlrev_b32 v112, 16, v212
    v_and_b32 v113, s76, v212
    v_lshlrev_b32 v114, 16, v213
    v_and_b32 v115, s76, v213
    v_lshlrev_b32 v116, 16, v214
    v_and_b32 v117, s76, v214
    v_lshlrev_b32 v118, 16, v215
    v_and_b32 v119, s76, v215
    v_lshlrev_b32 v120, 16, v216
    v_and_b32 v121, s76, v216
    v_lshlrev_b32 v122, 16, v217
    v_and_b32 v123, s76, v217
    v_lshlrev_b32 v124, 16, v218
    v_and_b32 v125, s76, v218
    v_lshlrev_b32 v126, 16, v219
    v_and_b32 v127, s76, v219
    v_lshlrev_b32 v128, 16, v220
    v_and_b32 v129, s76, v220
    v_lshlrev_b32 v130, 16, v221
    v_and_b32 v131, s76, v221
    v_lshlrev_b32 v132, 16, v222
    v_and_b32 v133, s76, v222
    v_lshlrev_b32 v134, 16, v223
    v_and_b32 v135, s76, v223
L_P3Q:
    s_cmp_lg_u32 s70, 5
    s_cbranch_scc1 L_only3253
    s_lshl_b32 s5, s68, 5
    v_and_b32 v249, 7, v1
    v_cmp_gt_u32 vcc, 4, v249
    v_lshlrev_b32 v249, 2, v249
    v_add_u32 v249, s5, v249
    v_mov_b32 v242, 0x1f1f1f1f
    v_mov_b32 v241, 0x1f1f1f1f
    v_cndmask_b32 v242, v242, v241, vcc
    s_mul_i32 s85, s71, 16843009
    v_and_b32 v241, 0xf8f8f8f8, v242
    v_or_b32 v241, s85, v241
    s_mov_b32 s87, 0
    s_mov_b32 s6, 0
    s_cmp_eq_u32 s92, 0
    s_cbranch_scc0 L_ps3255
L_pl3255:
    buffer_load_dword v247, v249, s[60:63], 0 offen sc1
    s_add_u32 s87, s87, 1
    s_waitcnt vmcnt(0)
    v_and_b32 v247, v242, v247
    v_cmp_ne_u32 vcc, v241, v247
    s_nop 1
    s_cmp_eq_u64 vcc, 0
    s_cbranch_scc1 L_pw3255
    s_cmp_lt_u32 s87, 400000
    s_cbranch_scc1 L_pl3255
    s_branch L_pw3255
L_ps3255:
    s_mov_b64 exec, 0xff
    v_mov_b32 v247, 0
    buffer_atomic_or v247, v249, s[60:63], 0 offen sc0 sc1
    s_add_u32 s87, s87, 1
    s_mov_b32 s3, 0x10101010
    s_waitcnt vmcnt(0)
    v_and_b32 v247, s3, v247
    v_cmp_ne_u32 vcc, s3, v247
    s_mov_b64 exec, -1
    s_nop 0
    s_cmp_eq_u64 vcc, 0
    s_cbranch_scc1 L_pw3255
    s_sleep 8
    s_cmp_lt_u32 s87, 400000
    s_cbranch_scc1 L_ps3255
L_pw3255:
L_only3253:
    s_barrier
    s_cmp_ge_u32 s70, 5
    s_cbranch_scc1 L_P3W5
    s_add_u32 s3, s96, 0
    s_mov_b32 m0, s3
    s_nop 0
    buffer_load_dwordx4 v240, s[52:55], 0 offen sc1 lds
    s_add_u32 s3, s96, 5120
    s_mov_b32 m0, s3
    s_nop 0
    buffer_load_dwordx4 v241, s[52:55], s82 offen sc1 lds
    s_add_u32 s3, s96, 10240
    s_mov_b32 m0, s3
    s_nop 0
    buffer_load_dwordx4 v242, s[52:55], s83 offen sc1 lds
    s_add_u32 s3, s96, 15360
    s_mov_b32 m0, s3
    s_nop 0
    buffer_load_dwordx4 v243, s[52:55], s84 offen sc1 lds
    s_waitcnt vmcnt(0)
    s_barrier
    ds_read_b128 v[88:91], v14 offset:0
    ds_read_b128 v[92:95], v14 offset:128
    ds_read_b128 v[96:99], v14 offset:256
    ds_read_b128 v[100:103], v14 offset:384
    s_cmp_eq_u32 s72, 0
    s_cbranch_scc1 L_P3A
    s_waitcnt lgkmcnt(3)
    v_lshlrev_b32 v140, 16, v88
    v_and_b32 v144, s76, v88
    v_lshlrev_b32 v148, 16, v89
    v_and_b32 v152, s76, v89
    v_lshlrev_b32 v156, 16, v90
    v_and_b32 v160, s76, v90
    v_lshlrev_b32 v164, 16, v91
    v_and_b32 v168, s76, v91
    s_waitcnt lgkmcnt(2)
    v_lshlrev_b32 v141, 16, v92
    v_and_b32 v145, s76, v92
    v_lshlrev_b32 v149, 16, v93
    v_and_b32 v153, s76, v93
    v_lshlrev_b32 v157, 16, v94
    v_and_b32 v161, s76, v94
    v_lshlrev_b32 v165, 16, v95
    v_and_b32 v169, s76, v95
    s_waitcnt lgkmcnt(1)
    v_lshlrev_b32 v142, 16, v96
    v_and_b32 v146, s76, v96
    v_lshlrev_b32 v150, 16, v97
    v_and_b32 v154, s76, v97
    v_lshlrev_b32 v158, 16, v98
    v_and_b32 v162, s76, v98
    v_lshlrev_b32 v166, 16, v99
    v_and_b32 v170, s76, v99
    s_waitcnt lgkmcnt(0)
    v_lshlrev_b32 v143, 16, v100
    v_and_b32 v147, s76, v100
    v_lshlrev_b32 v151, 16, v101
    v_and_b32 v155, s76, v101
    v_lshlrev_b32 v159, 16, v102
    v_and_b32 v163, s76, v102
    v_lshlrev_b32 v167, 16, v103
    v_and_b32 v171, s76, v103
    v_pk_mul_f32 v[140:141], v[140:141], v[104:105]
    v_pk_mul_f32 v[142:143], v[142:143], v[106:107]
    v_pk_mul_f32 v[144:145], v[144:145], v[108:109]
    v_pk_mul_f32 v[146:147], v[146:147], v[110:111]
    v_pk_mul_f32 v[148:149], v[148:149], v[112:113]
    v_pk_mul_f32 v[150:151], v[150:151], v[114:115]
    v_pk_mul_f32 v[152:153], v[152:153], v[116:117]
    v_pk_mul_f32 v[154:155], v[154:155], v[118:119]
    v_pk_mul_f32 v[156:157], v[156:157], v[120:121]
    v_pk_mul_f32 v[158:159], v[158:159], v[122:123]
    v_pk_mul_f32 v[160:161], v[160:161], v[124:125]
    v_pk_mul_f32 v[162:163], v[162:163], v[126:127]
    v_pk_mul_f32 v[164:165], v[164:165], v[128:129]
    v_pk_mul_f32 v[166:167], v[166:167], v[130:131]
    v_pk_mul_f32 v[168:169], v[168:169], v[132:133]
    v_pk_mul_f32 v[170:171], v[170:171], v[134:135]
    v_cvt_pk_bf16_f32 v176, v140, v141
    v_cvt_pk_bf16_f32 v177, v142, v143
    buffer_store_dwordx2 v[176:177], v12, s[56:59], 0 offen
    v_cvt_pk_bf16_f32 v178, v144, v145
    v_cvt_pk_bf16_f32 v179, v146, v147
    buffer_store_dwordx2 v[178:179], v12, s[56:59], 0 offen offset:2560
    v_cvt_pk_bf16_f32 v180, v148, v149
    v_cvt_pk_bf16_f32 v181, v150, v151
    buffer_store_dwordx2 v[180:181], v12, s[56:59], s80 offen
    v_cvt_pk_bf16_f32 v182, v152, v153
    v_cvt_pk_bf16_f32 v183, v154, v155
    buffer_store_dwordx2 v[182:183], v12, s[56:59], s81 offen
    v_cvt_pk_bf16_f32 v184, v156, v157
    v_cvt_pk_bf16_f32 v185, v158, v159
    buffer_store_dwordx2 v[184:185], v13, s[56:59], 0 offen
    v_cvt_pk_bf16_f32 v186, v160, v161
    v_cvt_pk_bf16_f32 v187, v162, v163
    buffer_store_dwordx2 v[186:187], v13, s[56:59], 0 offen offset:2560
    v_cvt_pk_bf16_f32 v188, v164, v165
    v_cvt_pk_bf16_f32 v189, v166, v167
    buffer_store_dwordx2 v[188:189], v13, s[56:59], s80 offen
    v_cvt_pk_bf16_f32 v190, v168, v169
    v_cvt_pk_bf16_f32 v191, v170, v171
    buffer_store_dwordx2 v[190:191], v13, s[56:59], s81 offen
    s_branch L_P3E
L_P3A:
    s_waitcnt lgkmcnt(0)
    v_perm_b32 v176, v92, v88, s77
    v_perm_b32 v177, v100, v96, s77
    buffer_store_dwordx2 v[176:177], v12, s[56:59], 0 offen
    v_perm_b32 v178, v92, v88, s78
    v_perm_b32 v179, v100, v96, s78
    buffer_store_dwordx2 v[178:179], v12, s[56:59], 0 offen offset:2560
    v_perm_b32 v180, v93, v89, s77
    v_perm_b32 v181, v101, v97, s77
    buffer_store_dwordx2 v[180:181], v12, s[56:59], s80 offen
    v_perm_b32 v182, v93, v89, s78
    v_perm_b32 v183, v101, v97, s78
    buffer_store_dwordx2 v[182:183], v12, s[56:59], s81 offen
    v_perm_b32 v184, v94, v90, s77
    v_perm_b32 v185, v102, v98, s77
    buffer_store_dwordx2 v[184:185], v13, s[56:59], 0 offen
    v_perm_b32 v186, v94, v90, s78
    v_perm_b32 v187, v102, v98, s78
    buffer_store_dwordx2 v[186:187], v13, s[56:59], 0 offen offset:2560
    v_perm_b32 v188, v95, v91, s77
    v_perm_b32 v189, v103, v99, s77
    buffer_store_dwordx2 v[188:189], v13, s[56:59], s80 offen
    v_perm_b32 v190, v95, v91, s78
    v_perm_b32 v191, v103, v99, s78
    buffer_store_dwordx2 v[190:191], v13, s[56:59], s81 offen
    s_branch L_P3E
L_P3W5:
    s_barrier
L_P3E:
L_END:
    s_endpgm
L_CODE_END:
.section .rodata,"a"
.p2align 6
.amdhsa_kernel concat_heads__ssm_conv_s4d__ssm_conv_h3__prompt_kernel
  .amdhsa_next_free_vgpr 256
  .amdhsa_next_free_sgpr 102
  .amdhsa_accum_offset 256
  .amdhsa_group_segment_fixed_size 0
  .amdhsa_kernarg_size 128
  .amdhsa_user_sgpr_count 2
  .amdhsa_user_sgpr_kernarg_segment_ptr 1
  .amdhsa_system_sgpr_workgroup_id_x 1
.end_amdhsa_kernel
```
